```python
import torch

def _softmax(x, axis=-1):
    return torch.softmax(x, dim=axis)
def _gelu(x):
    return torch.nn.functional.gelu(x, approximate="tanh")
def _silu(x):
    return torch.nn.functional.silu(x)
def _sigmoid(x):
    return torch.sigmoid(x)
def _layernorm(x, axis=-1, eps=1e-5):
    m = x.mean(dim=axis, keepdim=True)
    v = x.var(dim=axis, keepdim=True, unbiased=False)
    return (x - m) / torch.sqrt(v + eps)
def _scatter_add(tgt, idx, src, axis=0):
    return tgt.clone().index_add_(axis, idx, src)
def _segment_sum(src, seg, n):
    out = torch.zeros((n,) + src.shape[1:], dtype=src.dtype)
    return out.index_add_(0, seg, src)
def _pad(x, pw):
    flat = tuple(v for pair in reversed(pw) for v in pair)
    return torch.nn.functional.pad(x, flat)

kernel_name = 'gated_mix__linear_attn_block__glu_gated_swiglu__prompt'

def setup_inputs():

    _w = (lambda a: (lambda t: t.to(torch.bfloat16) if t.is_floating_point() else t)(torch.as_tensor(a)))
    def _A_setup():
        B, S, D = 1, 2048, 512
        return {
            "x": _w((lambda *s: torch.randn(*s, dtype=torch.bfloat16) * 0.05)(B, S, D)),
            "wqkv": _w((lambda *s: torch.randn(*s, dtype=torch.bfloat16) * 0.8)(D, 3 * D)),
            "wo": _w((lambda *s: torch.randn(*s, dtype=torch.bfloat16) * 0.05)(D, D)),
        }
    _A_in = _A_setup()

    def _B_setup():
        B, S, D, F = 1, 2048, 512, 1376
        return {
            "x": _w((lambda *s: torch.randn(*s, dtype=torch.bfloat16) * 0.05)(B, S, D)),
            "w1": _w((lambda *s: torch.randn(*s, dtype=torch.bfloat16) * 1.6)(D, F) * (2.0 / D) ** 0.5),
            "w3": _w((lambda *s: torch.randn(*s, dtype=torch.bfloat16) * 1.6)(D, F) * (2.0 / D) ** 0.5),
            "w2": _w((lambda *s: torch.randn(*s, dtype=torch.bfloat16) * 1.6)(F, D) * (2.0 / F) ** 0.5),
        }
    _B_in = _B_setup()

    return {
        "A_x": _A_in["x"],
        "A_wqkv": _A_in["wqkv"],
        "A_wo": _A_in["wo"],
        "B_x": _B_in["x"],
        "B_w1": _B_in["w1"],
        "B_w3": _B_in["w3"],
        "B_w2": _B_in["w2"],
        "gate_w": _w((lambda *s: torch.randn(*s, dtype=torch.bfloat16) * 0.05)(512) * 16.0),
    }

def reference(A_x, A_wqkv, A_wo, B_x, B_w1, B_w3, B_w2, gate_w):
    def _A_ref(x, wqkv, wo):
        B, S, D = x.shape
        H = 32; Dh = D // H
        qkv = (lambda x, *d: x.permute(*d))((x @ wqkv).reshape(B, S, 3, H, Dh), 2, 0, 3, 1, 4)
        q, k, v = qkv[0], qkv[1], qkv[2]
        phi = lambda t: torch.where(t > 0, t + 1, torch.exp(t)) + 1e-6
        pq, pk = phi(q), phi(k)
        kv = torch.einsum("bhsd,bhse->bhde", pk, v)
        z = torch.einsum("bhsd->bhd", pk)
        num = torch.einsum("bhqd,bhde->bhqe", pq, kv)
        den = torch.einsum("bhqd,bhd->bhq", pq, z)[..., None] + 1e-6
        o = num / den
        return (lambda x, *d: x.permute(*d))(o, 0, 2, 1, 3).reshape(B, S, D) @ wo

    def _B_ref(x, w1, w3, w2):
        gate = torch.einsum("bsd,df->bsf", x, w1)
        up = torch.einsum("bsd,df->bsf", x, w3)
        h = _silu(gate) * up
        out = torch.einsum("bsf,fd->bsd", h, w2)
        return out

    x = A_x
    g = _sigmoid((x * gate_w).sum(-1, keepdims=True))
    a = _A_ref(x, A_wqkv, A_wo)
    b = _B_ref(x, B_w1, B_w3, B_w2)
    return g * a + (1 - g) * b
```

```asm
; @launch grid=(256,1,1) block=(512,1,1) lds=156736
.amdgcn_target "amdgcn-amd-amdhsa--gfx950"
.text
.globl gated_mix__linear_attn_block__glu_gated_swiglu__prompt_kernel
.p2align 8
.type gated_mix__linear_attn_block__glu_gated_swiglu__prompt_kernel,@function
gated_mix__linear_attn_block__glu_gated_swiglu__prompt_kernel:
s_load_dwordx2 s[56:57], s[0:1], 0
v_lshrrev_b32 v1, 6, v0
v_and_b32 v2, 63, v0
s_cmpk_ge_u32 s2, 256
s_cbranch_scc1 L_end
v_readfirstlane_b32 s26, v1
s_and_b32 s38, s2, 7
s_cmp_eq_u32 s26, 0
s_cbranch_scc1 L_cons
s_cmp_eq_u32 s26, 1
s_cbranch_scc1 L_pad
s_cmp_eq_u32 s26, 2
s_cbranch_scc1 L_pad1
s_cmp_eq_u32 s26, 3
s_cbranch_scc1 L_pad2
s_and_b32 s40, s26, 6
s_lshl2_add_u32 s40, s40, 16
s_load_dwordx2 s[60:61], s[0:1], s40
s_lshr_b32 s39, s2, 3
s_cmp_ge_u32 s39, 30
s_cbranch_scc1 L_spec_l
s_lshl_b32 s42, s38, 1
s_lshr_b32 s41, 0x40a4, s42
s_bitcmp1_b32 0xc3, s38
s_cselect_b32 s43, 5, 6
s_cselect_b32 s44, 13, 11
s_mul_i32 s44, s44, s39
s_lshr_b32 s44, s44, 6
s_mul_i32 s43, s43, s44
s_sub_u32 s43, s39, s43
s_and_b32 s40, s38, 3
s_mul_i32 s40, s40, 5
s_add_u32 s44, s44, s40
s_and_b32 s40, s41, 3
s_add_u32 s28, s44, s40
s_lshr_b32 s40, s38, 2
s_mul_i32 s40, s40, 5
s_add_u32 s27, s40, s43
s_cmp_eq_u32 s43, 5
s_cselect_b32 s27, 10, s27
L_cell_l:
s_mul_i32 s29, s28, 43
s_lshr_b32 s29, s29, 7
s_add_u32 s40, s27, s28
s_lshr_b32 s40, s40, 1
s_and_b32 s40, s40, 1
s_lshl1_add_u32 s37, s26, s40
s_sub_u32 s37, s37, 8
s_lshl3_add_u32 s50, s27, s37
s_mulk_i32 s50, 24576
s_mul_i32 s33, s37, 3072
s_mov_b32 m0, s33
v_lshrrev_b32 v4, 3, v2
v_and_b32 v5, 6, v4
v_xor_b32 v5, v5, v2
v_and_b32 v5, 7, v5
v_lshlrev_b32 v6, 10, v4
v_lshl_add_u32 v10, v5, 4, v6
v_add_u32 v11, 7168, v10
v_add_u32 v12, 14336, v10
s_mov_b32 s58, 0x200000
s_mov_b32 s59, 0x20000
s_mov_b32 s63, s59
s_mov_b32 s62, 1409024
s_sub_u32 s96, s28, s29
s_mulk_i32 s96, 192
s_and_b32 s40, s37, 3
s_mul_i32 s40, s40, 44032
s_add_u32 s96, s96, s40
s_addk_i32 s96, -192
v_lshrrev_b32 v6, 2, v2
v_mul_u32_u24 v6, 43, v6
v_lshrrev_b32 v13, 7, v6
v_add_u32 v14, 688, v6
v_lshrrev_b32 v14, 7, v14
v_add_u32 v15, 1376, v6
v_lshrrev_b32 v15, 7, v15
v_lshlrev_b32 v7, 4, v2
v_and_b32 v8, 32, v2
v_xor_b32 v8, v8, v7
v_xor_b32 v9, 32, v7
s_movk_i32 s40, 2560
v_mad_u32_u24 v16, v13, s40, v7
v_mad_u32_u24 v17, v14, s40, v8
v_mad_u32_u24 v18, v15, s40, v9
s_bitcmp1_b32 0x649249, s28
s_waitcnt lgkmcnt(0)
buffer_load_dwordx4 v10, s[56:59], s50 offen offset:0 lds
buffer_load_dwordx4 v11, s[56:59], s50 offen offset:1024 lds
buffer_load_dwordx4 v12, s[56:59], s50 offen offset:2048 lds
s_cbranch_scc1 L_ld_other
s_addk_i32 m0, 24576
s_mov_b32 s30, 0
buffer_load_dwordx4 v16, s[60:63], s96 offen offset:0 lds
buffer_load_dwordx4 v17, s[60:63], s96 offen offset:1024 lds
buffer_load_dwordx4 v18, s[60:63], s96 offen offset:2048 lds
s_branch L_ld_w13
s_nop 0
s_nop 0
s_nop 0
s_nop 0
s_nop 0
s_nop 0
s_nop 0
s_nop 0
L_pad:
s_branch L_cons
L_spec_l:
s_mov_b32 s44, 0xf432aa10
s_mov_b32 s45, 0xff9876a5
s_and_b32 s43, s39, 1
s_lshl1_add_u32 s40, s38, s43
s_lshl_b32 s40, s40, 2
s_lshr_b64 s[44:45], s[44:45], s40
s_and_b32 s27, s44, 15
s_add_u32 s43, s43, 10
s_cmp_eq_u32 s38, 1
s_cselect_b32 s28, s43, 22
s_sub_u32 s48, s26, 4
s_cmp_eq_u32 s27, 15
s_cbranch_scc1 L_ld_idle
s_branch L_cell_l
L_ld_other:
s_addk_i32 m0, 24576
s_cmp_eq_u32 s28, 22
s_cbranch_scc0 L_ld_qkv
s_load_dwordx2 s[88:89], s[0:1], 56
s_movk_i32 s90, 1024
s_mov_b32 s91, 0x20000
v_mov_b32 v23, 2130706432
s_mov_b32 s30, 0
v_mad_i32_i24 v6, v13, -12, v2
v_cmp_gt_i32 vcc, 4, v6
s_nop 1
v_cndmask_b32 v16, v23, v16, vcc
v_mad_i32_i24 v6, v14, -12, v2
v_cmp_gt_i32 vcc, -60, v6
s_nop 1
v_cndmask_b32 v17, v23, v17, vcc
v_mad_i32_i24 v6, v15, -12, v2
v_cmp_gt_i32 vcc, -124, v6
s_nop 1
v_cndmask_b32 v18, v23, v18, vcc
buffer_load_dwordx4 v16, s[60:63], s96 offen offset:0 lds
buffer_load_dwordx4 v17, s[60:63], s96 offen offset:1024 lds
buffer_load_dwordx4 v18, s[60:63], s96 offen offset:2048 lds
s_mov_b32 m0, 147456
s_waitcnt lgkmcnt(0)
buffer_load_dwordx4 v7, s[88:91], 0 offen lds
s_branch L_ld_w13
L_ld_qkv:
s_load_dwordx2 s[60:61], s[0:1], 8
v_lshrrev_b32 v5, 2, v2
v_and_b32 v5, 4, v5
v_xor_b32 v5, v5, v2
v_and_b32 v5, 7, v5
v_mul_u32_u24 v6, 3072, v4
v_lshl_add_u32 v6, v5, 4, v6
s_and_b32 s40, s37, 1
s_lshl_b32 s40, s40, 5
s_xor_b32 s41, s29, 0
s_lshl_b32 s41, s41, 7
s_or_b32 s40, s40, s41
v_xor_b32 v16, s40, v6
v_xor_b32 v17, s40, v6
v_xor_b32 v18, s40, v6
v_xor_b32 v16, 128, v16
s_mul_i32 s96, s37, 24576
s_mov_b32 s49, 196608
s_mov_b32 s62, 1572864
s_mov_b32 s30, 32
s_xor_b32 s40, s37, 1
s_mul_i32 s97, s40, 24576
s_waitcnt lgkmcnt(0)
buffer_load_dwordx4 v16, s[60:63], s96 offen offset:0 lds
buffer_load_dwordx4 v17, s[60:63], s96 offen offset:1024 lds
buffer_load_dwordx4 v18, s[60:63], s96 offen offset:2048 lds
s_branch L_ld_go
L_ld_w13:
s_bitcmp1_b32 s37, 0
s_mov_b32 s40, 44032
s_cselect_b32 s40, -44032, s40
s_add_u32 s97, s96, s40
s_mov_b32 s49, 176128
L_ld_go:
v_xor_b32 v19, s30, v16
v_xor_b32 v20, s30, v17
v_xor_b32 v21, s30, v18
s_xor_b32 s40, s37, 1
s_mul_i32 s55, s40, 3072
s_lshl3_add_u32 s51, s27, s40
s_mulk_i32 s51, 24576
s_load_dwordx16 s[4:19], s[0:1], 0
s_load_dwordx4 s[20:23], s[0:1], 64
s_load_dwordx2 s[24:25], s[0:1], 80
s_add_u32 s40, s27, s28
s_bitcmp1_b32 s40, 0
s_mov_b32 s32, 0x76543210
s_cselect_b32 s32, 0x75634120, s32
s_bfe_u32 s46, s32, 0x30000
s_add_u32 m0, s55, 0
s_mul_i32 s45, s46, s49
s_lshl_b32 s46, s46, 7
s_add_u32 s46, s46, s51
buffer_load_dwordx4 v10, s[56:59], s46 offen offset:0 lds
buffer_load_dwordx4 v11, s[56:59], s46 offen offset:1024 lds
buffer_load_dwordx4 v12, s[56:59], s46 offen offset:2048 lds
s_addk_i32 m0, 24576
s_add_u32 s45, s45, s97
buffer_load_dwordx4 v19, s[60:63], s45 offen offset:0 lds
buffer_load_dwordx4 v20, s[60:63], s45 offen offset:1024 lds
buffer_load_dwordx4 v21, s[60:63], s45 offen offset:2048 lds
s_sub_u32 s48, s26, 4
s_waitcnt vmcnt(6)
s_bfe_u32 s46, s32, 0x30004
s_add_u32 m0, s33, 49152
s_mul_i32 s45, s46, s49
s_lshl_b32 s46, s46, 7
s_add_u32 s46, s46, s50
buffer_load_dwordx4 v10, s[56:59], s46 offen offset:0 lds
buffer_load_dwordx4 v11, s[56:59], s46 offen offset:1024 lds
buffer_load_dwordx4 v12, s[56:59], s46 offen offset:2048 lds
s_addk_i32 m0, 24576
s_add_u32 s45, s45, s96
buffer_load_dwordx4 v16, s[60:63], s45 offen offset:0 lds
buffer_load_dwordx4 v17, s[60:63], s45 offen offset:1024 lds
buffer_load_dwordx4 v18, s[60:63], s45 offen offset:2048 lds
s_waitcnt lgkmcnt(0)
s_and_b32 s38, s2, 6
s_lshr_b32 s39, s2, 5
s_lshl2_add_u32 s34, s38, s39
s_and_b32 s38, s2, 1
s_bfe_u32 s35, s2, 0x20003
s_lshl2_add_u32 s35, s38, s35
s_mov_b32 s72, s16
s_mov_b32 s73, s17
s_mov_b32 s74, 1409024
s_mov_b32 s75, 0x20000
s_mov_b32 s76, s8
s_mov_b32 s77, s9
s_mov_b32 s78, 524288
s_mov_b32 s79, 0x20000
s_mov_b32 s64, s24
s_mov_b32 s65, s25
s_mov_b32 s66, 268435456
s_mov_b32 s67, 0x20000
s_mov_b32 s68, s24
s_mov_b32 s69, s25
s_mov_b32 s70, 7733248
s_mov_b32 s71, 0x20000
s_mov_b32 s84, s22
s_mov_b32 s85, s23
s_mov_b32 s86, 256
s_mov_b32 s87, 0x20000
s_lshl3_add_u32 s38, s34, s35
s_lshl_b32 s38, s38, 8
s_add_u32 s38, s38, 9527296
s_add_u32 s28, s24, s38
s_addc_u32 s29, s25, 0
s_and_b32 s38, s34, 1
s_mul_i32 s36, s38, 6
s_bfe_u32 s38, s34, 0x10001
s_mul_i32 s38, s38, 3
s_add_u32 s36, s36, s38
v_lshrrev_b32 v22, 4, v2
v_and_b32 v23, 15, v2
v_lshlrev_b32 v4, 9, v22
v_lshl_add_u32 v4, v23, 4, v4
v_add_u32 v5, 120832, v4
v_lshlrev_b32 v13, 2, v23
v_lshrrev_b32 v24, 3, v2
v_lshrrev_b32 v25, 2, v2
v_and_b32 v25, 4, v25
v_xor_b32 v25, v25, v2
v_and_b32 v25, 7, v25
s_lshl_b32 s38, s35, 7
v_lshlrev_b32 v6, 10, v24
v_lshl_add_u32 v6, v25, 4, v6
v_add_u32 v6, s38, v6
v_xor_b32 v7, 32, v6
v_add_u32 v7, 7168, v7
v_add_u32 v28, 14336, v6
v_add_u32 v29, 14336, v7
s_mul_i32 s52, s48, 12288
v_bfe_u32 v24, v2, 1, 2
v_and_b32 v25, 1, v2
v_lshl_or_b32 v24, v25, 2, v24
v_xor_b32 v24, v24, v22
s_add_u32 s38, s52, 57344
v_lshlrev_b32 v24, 4, v24
v_lshl_add_u32 v24, v23, 7, v24
v_add_u32 v8, s38, v24
v_xor_b32 v9, 64, v8
v_bfe_u32 v24, v2, 2, 2
v_lshl_add_u32 v25, v22, 3, v24
v_and_b32 v24, 2, v24
v_and_b32 v22, 1, v22
v_or_b32 v24, v24, v22
v_and_b32 v23, 3, v2
v_lshlrev_b32 v25, 7, v25
v_lshl_add_u32 v25, v24, 5, v25
v_lshl_add_u32 v25, v23, 3, v25
v_add_u32 v160, s52, v25
v_xor_b32 v161, 32, v160
v_xor_b32 v162, 64, v160
v_xor_b32 v163, 96, v160
v_add_u32 v24, 49152, v160
v_add_u32 v25, 49152, v161
v_add_u32 v26, 49152, v162
v_add_u32 v27, 49152, v163
s_mul_i32 s53, s34, 241664
v_mov_b32 v22, 0
v_lshlrev_b32 v30, 10, v2
v_lshlrev_b32 v1, 7, v2
s_waitcnt vmcnt(6)
s_barrier
s_bfe_u32 s46, s32, 0x30004
s_add_u32 m0, s55, 49152
s_mul_i32 s45, s46, s49
s_lshl_b32 s46, s46, 7
s_add_u32 s46, s46, s51
buffer_load_dwordx4 v10, s[56:59], s46 offen offset:0 lds
buffer_load_dwordx4 v11, s[56:59], s46 offen offset:1024 lds
buffer_load_dwordx4 v12, s[56:59], s46 offen offset:2048 lds
s_addk_i32 m0, 24576
s_add_u32 s45, s45, s97
buffer_load_dwordx4 v19, s[60:63], s45 offen offset:0 lds
buffer_load_dwordx4 v20, s[60:63], s45 offen offset:1024 lds
buffer_load_dwordx4 v21, s[60:63], s45 offen offset:2048 lds
s_bfe_u32 s46, s32, 0x30008
s_add_u32 m0, s33, 98304
s_mul_i32 s45, s46, s49
s_lshl_b32 s46, s46, 7
s_add_u32 s46, s46, s50
buffer_load_dwordx4 v10, s[56:59], s46 offen offset:0 lds
buffer_load_dwordx4 v11, s[56:59], s46 offen offset:1024 lds
buffer_load_dwordx4 v12, s[56:59], s46 offen offset:2048 lds
s_addk_i32 m0, 24576
s_add_u32 s45, s45, s96
buffer_load_dwordx4 v16, s[60:63], s45 offen offset:0 lds
buffer_load_dwordx4 v17, s[60:63], s45 offen offset:1024 lds
buffer_load_dwordx4 v18, s[60:63], s45 offen offset:2048 lds
s_bfe_u32 s46, s32, 0x30008
s_add_u32 m0, s55, 98304
s_mul_i32 s45, s46, s49
s_lshl_b32 s46, s46, 7
s_add_u32 s46, s46, s51
buffer_load_dwordx4 v10, s[56:59], s46 offen offset:0 lds
buffer_load_dwordx4 v11, s[56:59], s46 offen offset:1024 lds
buffer_load_dwordx4 v12, s[56:59], s46 offen offset:2048 lds
s_addk_i32 m0, 24576
s_add_u32 s45, s45, s97
buffer_load_dwordx4 v19, s[60:63], s45 offen offset:0 lds
buffer_load_dwordx4 v20, s[60:63], s45 offen offset:1024 lds
buffer_load_dwordx4 v21, s[60:63], s45 offen offset:2048 lds
s_waitcnt vmcnt(12)
s_barrier
s_bfe_u32 s46, s32, 0x3000c
s_add_u32 m0, s33, 0
s_mul_i32 s45, s46, s49
s_lshl_b32 s46, s46, 7
s_add_u32 s46, s46, s50
buffer_load_dwordx4 v10, s[56:59], s46 offen offset:0 lds
buffer_load_dwordx4 v11, s[56:59], s46 offen offset:1024 lds
buffer_load_dwordx4 v12, s[56:59], s46 offen offset:2048 lds
s_addk_i32 m0, 24576
s_add_u32 s45, s45, s96
buffer_load_dwordx4 v16, s[60:63], s45 offen offset:0 lds
buffer_load_dwordx4 v17, s[60:63], s45 offen offset:1024 lds
buffer_load_dwordx4 v18, s[60:63], s45 offen offset:2048 lds
s_bfe_u32 s46, s32, 0x3000c
s_add_u32 m0, s55, 0
s_mul_i32 s45, s46, s49
s_lshl_b32 s46, s46, 7
s_add_u32 s46, s46, s51
buffer_load_dwordx4 v10, s[56:59], s46 offen offset:0 lds
buffer_load_dwordx4 v11, s[56:59], s46 offen offset:1024 lds
buffer_load_dwordx4 v12, s[56:59], s46 offen offset:2048 lds
s_addk_i32 m0, 24576
s_add_u32 s45, s45, s97
buffer_load_dwordx4 v19, s[60:63], s45 offen offset:0 lds
buffer_load_dwordx4 v20, s[60:63], s45 offen offset:1024 lds
buffer_load_dwordx4 v21, s[60:63], s45 offen offset:2048 lds
s_add_u32 s38, s36, 0
s_cmp_ge_u32 s38, 11
s_cselect_b32 s39, 11, 0
s_sub_u32 s38, s38, s39
s_lshl2_add_u32 s38, s38, s48
s_cmp_ge_u32 s38, 43
s_cselect_b32 s39, 134217728, s53
s_lshl_b32 s38, s38, 11
s_add_u32 s4, s38, s39
s_add_u32 s38, s36, 1
s_cmp_ge_u32 s38, 11
s_cselect_b32 s39, 11, 0
s_sub_u32 s38, s38, s39
s_lshl2_add_u32 s38, s38, s48
s_cmp_ge_u32 s38, 43
s_cselect_b32 s39, 134217728, s53
s_lshl_b32 s38, s38, 11
s_add_u32 s5, s38, s39
s_add_u32 s38, s36, 2
s_cmp_ge_u32 s38, 11
s_cselect_b32 s39, 11, 0
s_sub_u32 s38, s38, s39
s_lshl2_add_u32 s38, s38, s48
s_cmp_ge_u32 s38, 43
s_cselect_b32 s39, 134217728, s53
s_lshl_b32 s38, s38, 11
s_add_u32 s6, s38, s39
s_add_u32 s38, s36, 3
s_cmp_ge_u32 s38, 11
s_cselect_b32 s39, 11, 0
s_sub_u32 s38, s38, s39
s_lshl2_add_u32 s38, s38, s48
s_cmp_ge_u32 s38, 43
s_cselect_b32 s39, 134217728, s53
s_lshl_b32 s38, s38, 11
s_add_u32 s7, s38, s39
s_add_u32 s38, s36, 4
s_cmp_ge_u32 s38, 11
s_cselect_b32 s39, 11, 0
s_sub_u32 s38, s38, s39
s_lshl2_add_u32 s38, s38, s48
s_cmp_ge_u32 s38, 43
s_cselect_b32 s39, 134217728, s53
s_lshl_b32 s38, s38, 11
s_add_u32 s8, s38, s39
s_add_u32 s38, s36, 5
s_cmp_ge_u32 s38, 11
s_cselect_b32 s39, 11, 0
s_sub_u32 s38, s38, s39
s_lshl2_add_u32 s38, s38, s48
s_cmp_ge_u32 s38, 43
s_cselect_b32 s39, 134217728, s53
s_lshl_b32 s38, s38, 11
s_add_u32 s9, s38, s39
s_add_u32 s38, s36, 6
s_cmp_ge_u32 s38, 11
s_cselect_b32 s39, 11, 0
s_sub_u32 s38, s38, s39
s_lshl2_add_u32 s38, s38, s48
s_cmp_ge_u32 s38, 43
s_cselect_b32 s39, 134217728, s53
s_lshl_b32 s38, s38, 11
s_add_u32 s10, s38, s39
s_add_u32 s38, s36, 7
s_cmp_ge_u32 s38, 11
s_cselect_b32 s39, 11, 0
s_sub_u32 s38, s38, s39
s_lshl2_add_u32 s38, s38, s48
s_cmp_ge_u32 s38, 43
s_cselect_b32 s39, 134217728, s53
s_lshl_b32 s38, s38, 11
s_add_u32 s11, s38, s39
s_add_u32 s38, s36, 8
s_cmp_ge_u32 s38, 11
s_cselect_b32 s39, 11, 0
s_sub_u32 s38, s38, s39
s_lshl2_add_u32 s38, s38, s48
s_cmp_ge_u32 s38, 43
s_cselect_b32 s39, 134217728, s53
s_lshl_b32 s38, s38, 11
s_add_u32 s12, s38, s39
s_add_u32 s38, s36, 9
s_cmp_ge_u32 s38, 11
s_cselect_b32 s39, 11, 0
s_sub_u32 s38, s38, s39
s_lshl2_add_u32 s38, s38, s48
s_cmp_ge_u32 s38, 43
s_cselect_b32 s39, 134217728, s53
s_lshl_b32 s38, s38, 11
s_add_u32 s13, s38, s39
s_add_u32 s38, s36, 10
s_cmp_ge_u32 s38, 11
s_cselect_b32 s39, 11, 0
s_sub_u32 s38, s38, s39
s_lshl2_add_u32 s38, s38, s48
s_cmp_ge_u32 s38, 43
s_cselect_b32 s39, 134217728, s53
s_lshl_b32 s38, s38, 11
s_add_u32 s14, s38, s39
s_waitcnt vmcnt(12)
s_barrier
s_bfe_u32 s46, s32, 0x30010
s_add_u32 m0, s33, 49152
s_mul_i32 s45, s46, s49
s_lshl_b32 s46, s46, 7
s_add_u32 s46, s46, s50
buffer_load_dwordx4 v10, s[56:59], s46 offen offset:0 lds
buffer_load_dwordx4 v11, s[56:59], s46 offen offset:1024 lds
buffer_load_dwordx4 v12, s[56:59], s46 offen offset:2048 lds
s_addk_i32 m0, 24576
s_add_u32 s45, s45, s96
buffer_load_dwordx4 v16, s[60:63], s45 offen offset:0 lds
buffer_load_dwordx4 v17, s[60:63], s45 offen offset:1024 lds
buffer_load_dwordx4 v18, s[60:63], s45 offen offset:2048 lds
s_bfe_u32 s46, s32, 0x30010
s_add_u32 m0, s55, 49152
s_mul_i32 s45, s46, s49
s_lshl_b32 s46, s46, 7
s_add_u32 s46, s46, s51
buffer_load_dwordx4 v10, s[56:59], s46 offen offset:0 lds
buffer_load_dwordx4 v11, s[56:59], s46 offen offset:1024 lds
buffer_load_dwordx4 v12, s[56:59], s46 offen offset:2048 lds
s_addk_i32 m0, 24576
s_add_u32 s45, s45, s97
buffer_load_dwordx4 v19, s[60:63], s45 offen offset:0 lds
buffer_load_dwordx4 v20, s[60:63], s45 offen offset:1024 lds
buffer_load_dwordx4 v21, s[60:63], s45 offen offset:2048 lds
s_lshl_b32 s54, s48, 17
s_lshl_b32 s38, s48, 13
s_add_u32 s38, s38, s53
s_add_u32 s80, s38, 88064
s_add_u32 s81, s80, 4096
s_lshl_b32 s44, s34, 8
s_add_u32 s44, s44, 7864320
s_xor_b32 s41, s44, 128
s_mov_b32 s42, 0x42200000
s_mov_b32 s43, 0xbfb8aa3b
s_waitcnt vmcnt(12)
s_barrier
s_bfe_u32 s46, s32, 0x30014
s_add_u32 m0, s33, 98304
s_mul_i32 s45, s46, s49
s_lshl_b32 s46, s46, 7
s_add_u32 s46, s46, s50
buffer_load_dwordx4 v10, s[56:59], s46 offen offset:0 lds
buffer_load_dwordx4 v11, s[56:59], s46 offen offset:1024 lds
buffer_load_dwordx4 v12, s[56:59], s46 offen offset:2048 lds
s_addk_i32 m0, 24576
s_add_u32 s45, s45, s96
buffer_load_dwordx4 v16, s[60:63], s45 offen offset:0 lds
buffer_load_dwordx4 v17, s[60:63], s45 offen offset:1024 lds
buffer_load_dwordx4 v18, s[60:63], s45 offen offset:2048 lds
s_bfe_u32 s46, s32, 0x30014
s_add_u32 m0, s55, 98304
s_mul_i32 s45, s46, s49
s_lshl_b32 s46, s46, 7
s_add_u32 s46, s46, s51
buffer_load_dwordx4 v10, s[56:59], s46 offen offset:0 lds
buffer_load_dwordx4 v11, s[56:59], s46 offen offset:1024 lds
buffer_load_dwordx4 v12, s[56:59], s46 offen offset:2048 lds
s_addk_i32 m0, 24576
s_add_u32 s45, s45, s97
buffer_load_dwordx4 v19, s[60:63], s45 offen offset:0 lds
buffer_load_dwordx4 v20, s[60:63], s45 offen offset:1024 lds
buffer_load_dwordx4 v21, s[60:63], s45 offen offset:2048 lds
s_waitcnt vmcnt(12)
s_barrier
s_bfe_u32 s46, s32, 0x30018
s_add_u32 m0, s33, 0
s_mul_i32 s45, s46, s49
s_lshl_b32 s46, s46, 7
s_add_u32 s46, s46, s50
buffer_load_dwordx4 v10, s[56:59], s46 offen offset:0 lds
buffer_load_dwordx4 v11, s[56:59], s46 offen offset:1024 lds
buffer_load_dwordx4 v12, s[56:59], s46 offen offset:2048 lds
s_addk_i32 m0, 24576
s_add_u32 s45, s45, s96
buffer_load_dwordx4 v16, s[60:63], s45 offen offset:0 lds
buffer_load_dwordx4 v17, s[60:63], s45 offen offset:1024 lds
buffer_load_dwordx4 v18, s[60:63], s45 offen offset:2048 lds
s_lshr_b32 s38, s2, 3
s_lshl2_add_u32 s38, s38, s48
s_mul_i32 s38, s38, 11264
s_bitcmp1_b32 s2, 0
s_cselect_b32 s38, 2130706432, s38
s_mov_b32 exec_lo, 0x7ff
s_mov_b32 exec_hi, 0
buffer_load_dword v31, v30, s[72:75], s38 offen offset:384
s_mov_b64 exec, -1
s_bfe_u32 s46, s32, 0x30018
s_add_u32 m0, s55, 0
s_mul_i32 s45, s46, s49
s_lshl_b32 s46, s46, 7
s_add_u32 s46, s46, s51
buffer_load_dwordx4 v10, s[56:59], s46 offen offset:0 lds
buffer_load_dwordx4 v11, s[56:59], s46 offen offset:1024 lds
buffer_load_dwordx4 v12, s[56:59], s46 offen offset:2048 lds
s_addk_i32 m0, 24576
s_add_u32 s45, s45, s97
buffer_load_dwordx4 v19, s[60:63], s45 offen offset:0 lds
buffer_load_dwordx4 v20, s[60:63], s45 offen offset:1024 lds
buffer_load_dwordx4 v21, s[60:63], s45 offen offset:2048 lds
s_getpc_b64 s[38:39]
L_pc2:
s_bfe_u32 s40, s2, 0x20003
s_lshl2_add_u32 s40, s40, s48
s_lshl_b32 s40, s40, 11
v_add_u32 v14, s40, v1
v_min_u32 v14, L_end-L_pc2, v14
s_mov_b32 exec_lo, 0xffff
s_mov_b32 exec_hi, 0
global_load_dword v31, v14, s[38:39]
s_mov_b64 exec, -1
s_waitcnt vmcnt(14)
s_barrier
buffer_load_dword v23, v22, s[84:87], 0 offen sc1
s_bfe_u32 s46, s32, 0x3001c
s_add_u32 m0, s33, 49152
s_mul_i32 s45, s46, s49
s_lshl_b32 s46, s46, 7
s_add_u32 s46, s46, s50
buffer_load_dwordx4 v10, s[56:59], s46 offen offset:0 lds
buffer_load_dwordx4 v11, s[56:59], s46 offen offset:1024 lds
buffer_load_dwordx4 v12, s[56:59], s46 offen offset:2048 lds
s_addk_i32 m0, 24576
s_add_u32 s45, s45, s96
buffer_load_dwordx4 v16, s[60:63], s45 offen offset:0 lds
buffer_load_dwordx4 v17, s[60:63], s45 offen offset:1024 lds
buffer_load_dwordx4 v18, s[60:63], s45 offen offset:2048 lds
s_bfe_u32 s46, s32, 0x3001c
s_add_u32 m0, s55, 49152
s_mul_i32 s45, s46, s49
s_lshl_b32 s46, s46, 7
s_add_u32 s46, s46, s51
buffer_load_dwordx4 v10, s[56:59], s46 offen offset:0 lds
buffer_load_dwordx4 v11, s[56:59], s46 offen offset:1024 lds
buffer_load_dwordx4 v12, s[56:59], s46 offen offset:2048 lds
s_addk_i32 m0, 24576
s_add_u32 s45, s45, s97
buffer_load_dwordx4 v19, s[60:63], s45 offen offset:0 lds
buffer_load_dwordx4 v20, s[60:63], s45 offen offset:1024 lds
buffer_load_dwordx4 v21, s[60:63], s45 offen offset:2048 lds
s_waitcnt vmcnt(14)
s_barrier
s_add_u32 m0, s52, 98304
s_sub_u32 s38, s4, s53
s_lshl_b32 s38, s38, 4
buffer_load_dwordx4 v6, s[72:75], s38 offen offset:0 lds
buffer_load_dwordx4 v7, s[72:75], s38 offen offset:1024 lds
buffer_load_dwordx4 v28, s[72:75], s38 offen offset:2048 lds
buffer_load_dwordx4 v29, s[72:75], s38 offen offset:3072 lds
s_add_u32 m0, s52, 102400
s_sub_u32 s38, s5, s53
s_lshl_b32 s38, s38, 4
buffer_load_dwordx4 v6, s[72:75], s38 offen offset:0 lds
buffer_load_dwordx4 v7, s[72:75], s38 offen offset:1024 lds
buffer_load_dwordx4 v28, s[72:75], s38 offen offset:2048 lds
buffer_load_dwordx4 v29, s[72:75], s38 offen offset:3072 lds
s_add_u32 m0, s52, 106496
s_sub_u32 s38, s6, s53
s_lshl_b32 s38, s38, 4
buffer_load_dwordx4 v6, s[72:75], s38 offen offset:0 lds
buffer_load_dwordx4 v7, s[72:75], s38 offen offset:1024 lds
buffer_load_dwordx4 v28, s[72:75], s38 offen offset:2048 lds
buffer_load_dwordx4 v29, s[72:75], s38 offen offset:3072 lds
s_waitcnt vmcnt(12)
v_cmp_gt_u32 vcc, 3, v23
s_nop 0
s_cmp_eq_u64 vcc, 0
s_cbranch_scc1 L_clr_ok
s_mov_b32 s47, 131072
s_mov_b32 exec_lo, 1
s_mov_b32 exec_hi, 0
L_clr1_loop:
buffer_load_dword v23, v22, s[84:87], 0 offen sc1
s_waitcnt vmcnt(0)
v_cmp_gt_u32 vcc, 3, v23
s_nop 0
s_cmp_eq_u64 vcc, 0
s_cbranch_scc1 L_clr1_done
s_sleep 1
s_sub_u32 s47, s47, 1
s_cmp_lg_u32 s47, 0
s_cbranch_scc1 L_clr1_loop
L_clr1_done:
s_mov_b64 exec, -1
L_clr_ok:
s_barrier
L_ld_tail:
s_lshr_b32 s38, s2, 3
s_lshl2_add_u32 s38, s38, s48
s_lshl_b32 s38, s38, 12
s_bitcmp1_b32 s2, 0
s_mov_b32 s39, 0x0f0f0f0f
s_cselect_b32 exec_lo, 0xf0f0f0f0, s39
s_mov_b32 exec_hi, 0
buffer_load_dword v31, v1, s[76:79], s38 offen
s_mov_b64 exec, -1
s_add_u32 m0, s52, 0
s_sub_u32 s38, s7, s53
s_lshl_b32 s38, s38, 4
buffer_load_dwordx4 v6, s[72:75], s38 offen offset:0 lds
buffer_load_dwordx4 v7, s[72:75], s38 offen offset:1024 lds
buffer_load_dwordx4 v28, s[72:75], s38 offen offset:2048 lds
buffer_load_dwordx4 v29, s[72:75], s38 offen offset:3072 lds
v_mov_b64 v[20:21], v[160:161]
v_mov_b64 v[22:23], v[162:163]
s_waitcnt vmcnt(5)
ds_read_b64_tr_b16 v[32:33], v24 offset:49152
ds_read_b64_tr_b16 v[34:35], v24 offset:49664
ds_read_b64_tr_b16 v[36:37], v25 offset:49152
ds_read_b64_tr_b16 v[38:39], v25 offset:49664
ds_read_b64_tr_b16 v[40:41], v26 offset:49152
ds_read_b64_tr_b16 v[42:43], v26 offset:49664
ds_read_b64_tr_b16 v[44:45], v27 offset:49152
ds_read_b64_tr_b16 v[46:47], v27 offset:49664
ds_read_b64_tr_b16 v[48:49], v24 offset:53248
ds_read_b64_tr_b16 v[50:51], v24 offset:53760
ds_read_b64_tr_b16 v[52:53], v25 offset:53248
ds_read_b64_tr_b16 v[54:55], v25 offset:53760
ds_read_b64_tr_b16 v[56:57], v26 offset:53248
ds_read_b64_tr_b16 v[58:59], v26 offset:53760
ds_read_b64_tr_b16 v[60:61], v27 offset:53248
ds_read_b64_tr_b16 v[62:63], v27 offset:53760
ds_read_b64_tr_b16 v[64:65], v24 offset:57344
ds_read_b64_tr_b16 v[66:67], v24 offset:57856
ds_read_b64_tr_b16 v[68:69], v25 offset:57344
ds_read_b64_tr_b16 v[70:71], v25 offset:57856
ds_read_b64_tr_b16 v[72:73], v26 offset:57344
ds_read_b64_tr_b16 v[74:75], v26 offset:57856
ds_read_b64_tr_b16 v[76:77], v27 offset:57344
ds_read_b64_tr_b16 v[78:79], v27 offset:57856
s_add_u32 m0, s52, 4096
s_sub_u32 s38, s8, s53
s_lshl_b32 s38, s38, 4
buffer_load_dwordx4 v6, s[72:75], s38 offen offset:0 lds
buffer_load_dwordx4 v7, s[72:75], s38 offen offset:1024 lds
buffer_load_dwordx4 v28, s[72:75], s38 offen offset:2048 lds
buffer_load_dwordx4 v29, s[72:75], s38 offen offset:3072 lds
s_add_u32 m0, s52, 8192
s_sub_u32 s38, s9, s53
s_lshl_b32 s38, s38, 4
buffer_load_dwordx4 v6, s[72:75], s38 offen offset:0 lds
buffer_load_dwordx4 v7, s[72:75], s38 offen offset:1024 lds
buffer_load_dwordx4 v28, s[72:75], s38 offen offset:2048 lds
buffer_load_dwordx4 v29, s[72:75], s38 offen offset:3072 lds
s_waitcnt lgkmcnt(0)
s_add_u32 m0, s52, 98304
s_sub_u32 s38, s10, s53
s_lshl_b32 s38, s38, 4
buffer_load_dwordx4 v6, s[72:75], s38 offen offset:0 lds
buffer_load_dwordx4 v7, s[72:75], s38 offen offset:1024 lds
buffer_load_dwordx4 v28, s[72:75], s38 offen offset:2048 lds
buffer_load_dwordx4 v29, s[72:75], s38 offen offset:3072 lds
s_add_u32 m0, s52, 102400
s_sub_u32 s38, s11, s53
s_lshl_b32 s38, s38, 4
buffer_load_dwordx4 v6, s[72:75], s38 offen offset:0 lds
buffer_load_dwordx4 v7, s[72:75], s38 offen offset:1024 lds
buffer_load_dwordx4 v28, s[72:75], s38 offen offset:2048 lds
buffer_load_dwordx4 v29, s[72:75], s38 offen offset:3072 lds
s_waitcnt vmcnt(8)
ds_read_b64_tr_b16 v[80:81], v20 offset:0
ds_read_b64_tr_b16 v[82:83], v20 offset:512
ds_read_b64_tr_b16 v[84:85], v21 offset:0
ds_read_b64_tr_b16 v[86:87], v21 offset:512
ds_read_b64_tr_b16 v[88:89], v22 offset:0
ds_read_b64_tr_b16 v[90:91], v22 offset:512
ds_read_b64_tr_b16 v[92:93], v23 offset:0
ds_read_b64_tr_b16 v[94:95], v23 offset:512
ds_read_b64_tr_b16 v[96:97], v20 offset:4096
ds_read_b64_tr_b16 v[98:99], v20 offset:4608
ds_read_b64_tr_b16 v[100:101], v21 offset:4096
ds_read_b64_tr_b16 v[102:103], v21 offset:4608
ds_read_b64_tr_b16 v[104:105], v22 offset:4096
ds_read_b64_tr_b16 v[106:107], v22 offset:4608
ds_read_b64_tr_b16 v[108:109], v23 offset:4096
ds_read_b64_tr_b16 v[110:111], v23 offset:4608
ds_read_b64_tr_b16 v[112:113], v20 offset:8192
ds_read_b64_tr_b16 v[114:115], v20 offset:8704
ds_read_b64_tr_b16 v[116:117], v21 offset:8192
ds_read_b64_tr_b16 v[118:119], v21 offset:8704
ds_read_b64_tr_b16 v[120:121], v22 offset:8192
ds_read_b64_tr_b16 v[122:123], v22 offset:8704
ds_read_b64_tr_b16 v[124:125], v23 offset:8192
ds_read_b64_tr_b16 v[126:127], v23 offset:8704
s_add_u32 m0, s52, 106496
s_sub_u32 s38, s12, s53
s_lshl_b32 s38, s38, 4
buffer_load_dwordx4 v6, s[72:75], s38 offen offset:0 lds
buffer_load_dwordx4 v7, s[72:75], s38 offen offset:1024 lds
buffer_load_dwordx4 v28, s[72:75], s38 offen offset:2048 lds
buffer_load_dwordx4 v29, s[72:75], s38 offen offset:3072 lds
s_waitcnt lgkmcnt(0)
s_add_u32 m0, s52, 0
s_add_u32 s38, s54, 0
s_waitcnt vmcnt(3)
buffer_load_dwordx4 v6, s[76:79], s38 offen offset:0 lds
s_waitcnt vmcnt(3)
buffer_load_dwordx4 v7, s[76:79], s38 offen offset:1024 lds
s_waitcnt vmcnt(3)
buffer_load_dwordx4 v28, s[76:79], s38 offen offset:2048 lds
s_waitcnt vmcnt(3)
buffer_load_dwordx4 v29, s[76:79], s38 offen offset:3072 lds
s_add_u32 m0, s52, 4096
s_add_u32 s38, s54, 32768
s_waitcnt vmcnt(3)
buffer_load_dwordx4 v6, s[76:79], s38 offen offset:0 lds
s_waitcnt vmcnt(3)
buffer_load_dwordx4 v7, s[76:79], s38 offen offset:1024 lds
s_waitcnt vmcnt(3)
buffer_load_dwordx4 v28, s[76:79], s38 offen offset:2048 lds
s_waitcnt vmcnt(3)
buffer_load_dwordx4 v29, s[76:79], s38 offen offset:3072 lds
s_barrier
s_add_u32 m0, s52, 49152
s_add_u32 s38, s54, 98304
buffer_load_dwordx4 v6, s[76:79], s38 offen offset:0 lds
buffer_load_dwordx4 v7, s[76:79], s38 offen offset:1024 lds
buffer_load_dwordx4 v28, s[76:79], s38 offen offset:2048 lds
buffer_load_dwordx4 v29, s[76:79], s38 offen offset:3072 lds
s_add_u32 m0, s52, 53248
s_sub_u32 s38, s13, s53
s_lshl_b32 s38, s38, 4
buffer_load_dwordx4 v6, s[72:75], s38 offen offset:0 lds
buffer_load_dwordx4 v7, s[72:75], s38 offen offset:1024 lds
buffer_load_dwordx4 v28, s[72:75], s38 offen offset:2048 lds
buffer_load_dwordx4 v29, s[72:75], s38 offen offset:3072 lds
s_add_u32 m0, s52, 57344
s_sub_u32 s38, s14, s53
s_lshl_b32 s38, s38, 4
buffer_load_dwordx4 v6, s[72:75], s38 offen offset:0 lds
buffer_load_dwordx4 v7, s[72:75], s38 offen offset:1024 lds
buffer_load_dwordx4 v28, s[72:75], s38 offen offset:2048 lds
buffer_load_dwordx4 v29, s[72:75], s38 offen offset:3072 lds
s_add_u32 m0, s52, 8192
s_add_u32 s38, s54, 65536
buffer_load_dwordx4 v6, s[76:79], s38 offen offset:0 lds
buffer_load_dwordx4 v7, s[76:79], s38 offen offset:1024 lds
buffer_load_dwordx4 v28, s[76:79], s38 offen offset:2048 lds
buffer_load_dwordx4 v29, s[76:79], s38 offen offset:3072 lds
s_cmp_eq_u32 s30, 0
s_cbranch_scc1 L_h_bar
v_mov_b32 v10, 156672
v_mov_b32 v11, 1
s_cmp_eq_u32 s48, 0
s_cbranch_scc0 L_hsr
s_mov_b32 s47, 131072
L_hs_loop:
s_load_dwordx8 s[84:91], s[28:29], 0 glc
s_load_dwordx8 s[92:99], s[28:29], 128 glc
L_hs_chk:
s_waitcnt lgkmcnt(0)
s_and_b64 s[84:85], s[84:85], s[86:87]
s_and_b64 s[88:89], s[88:89], s[90:91]
s_and_b64 s[92:93], s[92:93], s[94:95]
s_and_b64 s[96:97], s[96:97], s[84:85]
s_and_b64 s[88:89], s[88:89], s[92:93]
s_and_b64 s[96:97], s[96:97], s[88:89]
s_and_b32 s96, s96, s98
s_and_b32 s96, s96, s97
s_cbranch_scc1 L_hs_done
s_sub_u32 s47, s47, 1
s_cmp_lg_u32 s47, 0
s_cbranch_scc1 L_hs_loop
L_hs_done:
ds_write_b32 v10, v11 offset:12
s_branch L_hsr_done
L_hsr:
s_mov_b32 s47, 1048576
L_hsr_loop:
ds_read_b32 v12, v10 offset:12
s_waitcnt lgkmcnt(0)
v_readfirstlane_b32 s38, v12
s_nop 0
s_cmp_eq_u32 s38, 1
s_cbranch_scc1 L_hsr_done
s_sub_u32 s47, s47, 1
s_cmp_lg_u32 s47, 0
s_cbranch_scc1 L_hsr_loop
L_hsr_done:
s_branch L_h_ok
L_h_bar:
s_barrier
L_h_ok:
s_setprio 1
buffer_load_dwordx4 v[128:131], v4, s[68:71], s4 offen offset:0 sc1
buffer_load_dwordx4 v[132:135], v4, s[68:71], s4 offen offset:256 sc1
buffer_load_dwordx4 v[136:139], v5, s[68:71], s4 offen offset:0 sc1
buffer_load_dwordx4 v[140:143], v5, s[68:71], s4 offen offset:256 sc1
buffer_load_dwordx4 v[144:147], v4, s[68:71], s5 offen offset:0 sc1
buffer_load_dwordx4 v[148:151], v4, s[68:71], s5 offen offset:256 sc1
buffer_load_dwordx4 v[152:155], v5, s[68:71], s5 offen offset:0 sc1
buffer_load_dwordx4 v[156:159], v5, s[68:71], s5 offen offset:256 sc1
s_waitcnt vmcnt(7)
v_mfma_f32_16x16x32_bf16 v[192:195], v[32:35], v[128:131], 0
v_mfma_f32_16x16x32_bf16 v[196:199], v[36:39], v[128:131], 0
v_mfma_f32_16x16x32_bf16 v[200:203], v[40:43], v[128:131], 0
v_mfma_f32_16x16x32_bf16 v[204:207], v[44:47], v[128:131], 0
buffer_load_dwordx4 v[128:131], v4, s[68:71], s6 offen offset:0 sc1
s_waitcnt vmcnt(7)
v_mfma_f32_16x16x32_bf16 v[220:223], v[44:47], v[132:135], 0
v_mfma_f32_16x16x32_bf16 v[216:219], v[40:43], v[132:135], 0
v_mfma_f32_16x16x32_bf16 v[212:215], v[36:39], v[132:135], 0
v_mfma_f32_16x16x32_bf16 v[208:211], v[32:35], v[132:135], 0
buffer_load_dwordx4 v[132:135], v4, s[68:71], s6 offen offset:256 sc1
s_waitcnt vmcnt(7)
v_mfma_f32_16x16x32_bf16 v[224:227], v[32:35], v[136:139], 0
v_mfma_f32_16x16x32_bf16 v[228:231], v[36:39], v[136:139], 0
v_mfma_f32_16x16x32_bf16 v[232:235], v[40:43], v[136:139], 0
v_mfma_f32_16x16x32_bf16 v[236:239], v[44:47], v[136:139], 0
buffer_load_dwordx4 v[136:139], v5, s[68:71], s6 offen offset:0 sc1
s_waitcnt vmcnt(7)
v_mfma_f32_16x16x32_bf16 v[252:255], v[44:47], v[140:143], 0
v_mfma_f32_16x16x32_bf16 v[248:251], v[40:43], v[140:143], 0
v_mfma_f32_16x16x32_bf16 v[244:247], v[36:39], v[140:143], 0
v_mfma_f32_16x16x32_bf16 v[240:243], v[32:35], v[140:143], 0
buffer_load_dwordx4 v[140:143], v5, s[68:71], s6 offen offset:256 sc1
s_waitcnt vmcnt(7)
v_mfma_f32_16x16x32_bf16 v[192:195], v[48:51], v[144:147], v[192:195]
v_mfma_f32_16x16x32_bf16 v[196:199], v[52:55], v[144:147], v[196:199]
v_mfma_f32_16x16x32_bf16 v[200:203], v[56:59], v[144:147], v[200:203]
v_mfma_f32_16x16x32_bf16 v[204:207], v[60:63], v[144:147], v[204:207]
buffer_load_dwordx4 v[144:147], v4, s[68:71], s7 offen offset:0 sc1
s_waitcnt vmcnt(7)
v_mfma_f32_16x16x32_bf16 v[220:223], v[60:63], v[148:151], v[220:223]
v_mfma_f32_16x16x32_bf16 v[216:219], v[56:59], v[148:151], v[216:219]
v_mfma_f32_16x16x32_bf16 v[212:215], v[52:55], v[148:151], v[212:215]
v_mfma_f32_16x16x32_bf16 v[208:211], v[48:51], v[148:151], v[208:211]
buffer_load_dwordx4 v[148:151], v4, s[68:71], s7 offen offset:256 sc1
s_waitcnt vmcnt(7)
v_mfma_f32_16x16x32_bf16 v[224:227], v[48:51], v[152:155], v[224:227]
v_mfma_f32_16x16x32_bf16 v[228:231], v[52:55], v[152:155], v[228:231]
v_mfma_f32_16x16x32_bf16 v[232:235], v[56:59], v[152:155], v[232:235]
v_mfma_f32_16x16x32_bf16 v[236:239], v[60:63], v[152:155], v[236:239]
buffer_load_dwordx4 v[152:155], v5, s[68:71], s7 offen offset:0 sc1
s_waitcnt vmcnt(7)
v_mfma_f32_16x16x32_bf16 v[252:255], v[60:63], v[156:159], v[252:255]
v_mfma_f32_16x16x32_bf16 v[248:251], v[56:59], v[156:159], v[248:251]
v_mfma_f32_16x16x32_bf16 v[244:247], v[52:55], v[156:159], v[244:247]
v_mfma_f32_16x16x32_bf16 v[240:243], v[48:51], v[156:159], v[240:243]
buffer_load_dwordx4 v[156:159], v5, s[68:71], s7 offen offset:256 sc1
s_waitcnt vmcnt(7)
v_mfma_f32_16x16x32_bf16 v[192:195], v[64:67], v[128:131], v[192:195]
v_mfma_f32_16x16x32_bf16 v[196:199], v[68:71], v[128:131], v[196:199]
v_mfma_f32_16x16x32_bf16 v[200:203], v[72:75], v[128:131], v[200:203]
v_mfma_f32_16x16x32_bf16 v[204:207], v[76:79], v[128:131], v[204:207]
buffer_load_dwordx4 v[128:131], v4, s[68:71], s8 offen offset:0 sc1
s_waitcnt vmcnt(7)
v_mfma_f32_16x16x32_bf16 v[220:223], v[76:79], v[132:135], v[220:223]
v_mfma_f32_16x16x32_bf16 v[216:219], v[72:75], v[132:135], v[216:219]
v_mfma_f32_16x16x32_bf16 v[212:215], v[68:71], v[132:135], v[212:215]
v_mfma_f32_16x16x32_bf16 v[208:211], v[64:67], v[132:135], v[208:211]
buffer_load_dwordx4 v[132:135], v4, s[68:71], s8 offen offset:256 sc1
s_waitcnt vmcnt(7)
v_mfma_f32_16x16x32_bf16 v[224:227], v[64:67], v[136:139], v[224:227]
v_mfma_f32_16x16x32_bf16 v[228:231], v[68:71], v[136:139], v[228:231]
v_mfma_f32_16x16x32_bf16 v[232:235], v[72:75], v[136:139], v[232:235]
v_mfma_f32_16x16x32_bf16 v[236:239], v[76:79], v[136:139], v[236:239]
buffer_load_dwordx4 v[136:139], v4, s[68:71], s9 offen offset:0 sc1
s_waitcnt vmcnt(7)
v_mfma_f32_16x16x32_bf16 v[252:255], v[76:79], v[140:143], v[252:255]
v_mfma_f32_16x16x32_bf16 v[248:251], v[72:75], v[140:143], v[248:251]
v_mfma_f32_16x16x32_bf16 v[244:247], v[68:71], v[140:143], v[244:247]
v_mfma_f32_16x16x32_bf16 v[240:243], v[64:67], v[140:143], v[240:243]
buffer_load_dwordx4 v[140:143], v4, s[68:71], s9 offen offset:256 sc1
s_waitcnt vmcnt(7)
v_mfma_f32_16x16x32_bf16 v[192:195], v[80:83], v[144:147], v[192:195]
v_mfma_f32_16x16x32_bf16 v[196:199], v[84:87], v[144:147], v[196:199]
v_mfma_f32_16x16x32_bf16 v[200:203], v[88:91], v[144:147], v[200:203]
v_mfma_f32_16x16x32_bf16 v[204:207], v[92:95], v[144:147], v[204:207]
buffer_load_dwordx4 v[144:147], v4, s[68:71], s10 offen offset:0 sc1
s_waitcnt vmcnt(7)
v_mfma_f32_16x16x32_bf16 v[220:223], v[92:95], v[148:151], v[220:223]
v_mfma_f32_16x16x32_bf16 v[216:219], v[88:91], v[148:151], v[216:219]
v_mfma_f32_16x16x32_bf16 v[212:215], v[84:87], v[148:151], v[212:215]
v_mfma_f32_16x16x32_bf16 v[208:211], v[80:83], v[148:151], v[208:211]
buffer_load_dwordx4 v[148:151], v4, s[68:71], s10 offen offset:256 sc1
s_waitcnt vmcnt(7)
v_mfma_f32_16x16x32_bf16 v[224:227], v[80:83], v[152:155], v[224:227]
v_mfma_f32_16x16x32_bf16 v[228:231], v[84:87], v[152:155], v[228:231]
v_mfma_f32_16x16x32_bf16 v[232:235], v[88:91], v[152:155], v[232:235]
v_mfma_f32_16x16x32_bf16 v[236:239], v[92:95], v[152:155], v[236:239]
buffer_load_dwordx4 v[152:155], v5, s[68:71], s10 offen offset:0 sc1
s_waitcnt vmcnt(7)
v_mfma_f32_16x16x32_bf16 v[252:255], v[92:95], v[156:159], v[252:255]
v_mfma_f32_16x16x32_bf16 v[248:251], v[88:91], v[156:159], v[248:251]
v_mfma_f32_16x16x32_bf16 v[244:247], v[84:87], v[156:159], v[244:247]
v_mfma_f32_16x16x32_bf16 v[240:243], v[80:83], v[156:159], v[240:243]
buffer_load_dwordx4 v[156:159], v5, s[68:71], s10 offen offset:256 sc1
s_waitcnt vmcnt(7)
v_mfma_f32_16x16x32_bf16 v[192:195], v[96:99], v[128:131], v[192:195]
ds_read_b64_tr_b16 v[160:161], v24 offset:49152
ds_read_b64_tr_b16 v[162:163], v24 offset:49664
v_mfma_f32_16x16x32_bf16 v[196:199], v[100:103], v[128:131], v[196:199]
ds_read_b64_tr_b16 v[164:165], v25 offset:49152
ds_read_b64_tr_b16 v[166:167], v25 offset:49664
v_mfma_f32_16x16x32_bf16 v[200:203], v[104:107], v[128:131], v[200:203]
ds_read_b64_tr_b16 v[168:169], v26 offset:49152
ds_read_b64_tr_b16 v[170:171], v26 offset:49664
v_mfma_f32_16x16x32_bf16 v[204:207], v[108:111], v[128:131], v[204:207]
buffer_load_dwordx4 v[128:131], v4, s[68:71], s11 offen offset:0 sc1
s_waitcnt vmcnt(7)
v_mfma_f32_16x16x32_bf16 v[220:223], v[108:111], v[132:135], v[220:223]
ds_read_b64_tr_b16 v[172:173], v27 offset:49152
ds_read_b64_tr_b16 v[174:175], v27 offset:49664
v_mfma_f32_16x16x32_bf16 v[216:219], v[104:107], v[132:135], v[216:219]
ds_read_b64_tr_b16 v[32:33], v20 offset:0
ds_read_b64_tr_b16 v[34:35], v20 offset:512
v_mfma_f32_16x16x32_bf16 v[212:215], v[100:103], v[132:135], v[212:215]
ds_read_b64_tr_b16 v[36:37], v21 offset:0
ds_read_b64_tr_b16 v[38:39], v21 offset:512
v_mfma_f32_16x16x32_bf16 v[208:211], v[96:99], v[132:135], v[208:211]
buffer_load_dwordx4 v[132:135], v4, s[68:71], s11 offen offset:256 sc1
s_waitcnt vmcnt(7)
v_mfma_f32_16x16x32_bf16 v[192:195], v[112:115], v[136:139], v[192:195]
ds_read_b64_tr_b16 v[40:41], v22 offset:0
ds_read_b64_tr_b16 v[42:43], v22 offset:512
v_mfma_f32_16x16x32_bf16 v[196:199], v[116:119], v[136:139], v[196:199]
ds_read_b64_tr_b16 v[44:45], v23 offset:0
ds_read_b64_tr_b16 v[46:47], v23 offset:512
v_mfma_f32_16x16x32_bf16 v[200:203], v[120:123], v[136:139], v[200:203]
v_mfma_f32_16x16x32_bf16 v[204:207], v[124:127], v[136:139], v[204:207]
buffer_load_dwordx4 v[136:139], v5, s[68:71], s11 offen offset:0 sc1
s_waitcnt vmcnt(7)
v_mfma_f32_16x16x32_bf16 v[220:223], v[124:127], v[140:143], v[220:223]
v_mfma_f32_16x16x32_bf16 v[216:219], v[120:123], v[140:143], v[216:219]
buffer_load_dword v16, v13, s[64:67], s44 offen offset:0 sc1
buffer_load_dword v17, v13, s[64:67], s44 offen offset:64 sc1
v_mfma_f32_16x16x32_bf16 v[212:215], v[116:119], v[140:143], v[212:215]
buffer_load_dword v18, v13, s[64:67], s41 offen offset:0 sc1
buffer_load_dword v19, v13, s[64:67], s41 offen offset:64 sc1
v_mfma_f32_16x16x32_bf16 v[208:211], v[112:115], v[140:143], v[208:211]
buffer_load_dwordx4 v[140:143], v5, s[68:71], s11 offen offset:256 sc1
s_waitcnt vmcnt(11) lgkmcnt(8)
v_mfma_f32_16x16x32_bf16 v[192:195], v[160:163], v[144:147], v[192:195]
ds_read_b64_tr_b16 v[176:177], v24 offset:53248
ds_read_b64_tr_b16 v[178:179], v24 offset:53760
v_mfma_f32_16x16x32_bf16 v[196:199], v[164:167], v[144:147], v[196:199]
ds_read_b64_tr_b16 v[180:181], v25 offset:53248
ds_read_b64_tr_b16 v[182:183], v25 offset:53760
v_mfma_f32_16x16x32_bf16 v[200:203], v[168:171], v[144:147], v[200:203]
ds_read_b64_tr_b16 v[184:185], v26 offset:53248
ds_read_b64_tr_b16 v[186:187], v26 offset:53760
v_mfma_f32_16x16x32_bf16 v[204:207], v[172:175], v[144:147], v[204:207]
buffer_load_dwordx4 v[144:147], v4, s[68:71], s12 offen offset:0 sc1
s_waitcnt vmcnt(11)
v_mfma_f32_16x16x32_bf16 v[220:223], v[172:175], v[148:151], v[220:223]
ds_read_b64_tr_b16 v[188:189], v27 offset:53248
ds_read_b64_tr_b16 v[190:191], v27 offset:53760
v_mfma_f32_16x16x32_bf16 v[216:219], v[168:171], v[148:151], v[216:219]
ds_read_b64_tr_b16 v[48:49], v20 offset:4096
ds_read_b64_tr_b16 v[50:51], v20 offset:4608
v_mfma_f32_16x16x32_bf16 v[212:215], v[164:167], v[148:151], v[212:215]
ds_read_b64_tr_b16 v[52:53], v21 offset:4096
ds_read_b64_tr_b16 v[54:55], v21 offset:4608
v_mfma_f32_16x16x32_bf16 v[208:211], v[160:163], v[148:151], v[208:211]
buffer_load_dwordx4 v[148:151], v4, s[68:71], s12 offen offset:256 sc1
s_waitcnt vmcnt(11)
v_mfma_f32_16x16x32_bf16 v[224:227], v[160:163], v[152:155], v[224:227]
ds_read_b64_tr_b16 v[56:57], v22 offset:4096
ds_read_b64_tr_b16 v[58:59], v22 offset:4608
v_mfma_f32_16x16x32_bf16 v[228:231], v[164:167], v[152:155], v[228:231]
ds_read_b64_tr_b16 v[60:61], v23 offset:4096
ds_read_b64_tr_b16 v[62:63], v23 offset:4608
v_mfma_f32_16x16x32_bf16 v[232:235], v[168:171], v[152:155], v[232:235]
v_mfma_f32_16x16x32_bf16 v[236:239], v[172:175], v[152:155], v[236:239]
buffer_load_dwordx4 v[152:155], v5, s[68:71], s12 offen offset:0 sc1
s_waitcnt vmcnt(11)
v_mfma_f32_16x16x32_bf16 v[252:255], v[172:175], v[156:159], v[252:255]
v_mfma_f32_16x16x32_bf16 v[248:251], v[168:171], v[156:159], v[248:251]
v_mfma_f32_16x16x32_bf16 v[244:247], v[164:167], v[156:159], v[244:247]
v_mfma_f32_16x16x32_bf16 v[240:243], v[160:163], v[156:159], v[240:243]
buffer_load_dwordx4 v[156:159], v5, s[68:71], s12 offen offset:256 sc1
s_waitcnt vmcnt(11) lgkmcnt(8)
v_mfma_f32_16x16x32_bf16 v[192:195], v[176:179], v[128:131], v[192:195]
ds_read_b64_tr_b16 v[160:161], v24 offset:57344
ds_read_b64_tr_b16 v[162:163], v24 offset:57856
v_mfma_f32_16x16x32_bf16 v[196:199], v[180:183], v[128:131], v[196:199]
ds_read_b64_tr_b16 v[164:165], v25 offset:57344
ds_read_b64_tr_b16 v[166:167], v25 offset:57856
v_mfma_f32_16x16x32_bf16 v[200:203], v[184:187], v[128:131], v[200:203]
ds_read_b64_tr_b16 v[168:169], v26 offset:57344
ds_read_b64_tr_b16 v[170:171], v26 offset:57856
v_mfma_f32_16x16x32_bf16 v[204:207], v[188:191], v[128:131], v[204:207]
buffer_load_dwordx4 v[128:131], v4, s[68:71], s13 offen offset:0 sc1
s_waitcnt vmcnt(11)
v_mfma_f32_16x16x32_bf16 v[220:223], v[188:191], v[132:135], v[220:223]
ds_read_b64_tr_b16 v[172:173], v27 offset:57344
ds_read_b64_tr_b16 v[174:175], v27 offset:57856
v_mfma_f32_16x16x32_bf16 v[216:219], v[184:187], v[132:135], v[216:219]
ds_read_b64_tr_b16 v[64:65], v20 offset:8192
ds_read_b64_tr_b16 v[66:67], v20 offset:8704
v_mfma_f32_16x16x32_bf16 v[212:215], v[180:183], v[132:135], v[212:215]
ds_read_b64_tr_b16 v[68:69], v21 offset:8192
ds_read_b64_tr_b16 v[70:71], v21 offset:8704
v_mfma_f32_16x16x32_bf16 v[208:211], v[176:179], v[132:135], v[208:211]
buffer_load_dwordx4 v[132:135], v4, s[68:71], s13 offen offset:256 sc1
s_waitcnt vmcnt(11)
v_mfma_f32_16x16x32_bf16 v[224:227], v[176:179], v[136:139], v[224:227]
ds_read_b64_tr_b16 v[72:73], v22 offset:8192
ds_read_b64_tr_b16 v[74:75], v22 offset:8704
v_mfma_f32_16x16x32_bf16 v[228:231], v[180:183], v[136:139], v[228:231]
ds_read_b64_tr_b16 v[76:77], v23 offset:8192
ds_read_b64_tr_b16 v[78:79], v23 offset:8704
v_mfma_f32_16x16x32_bf16 v[232:235], v[184:187], v[136:139], v[232:235]
v_mfma_f32_16x16x32_bf16 v[236:239], v[188:191], v[136:139], v[236:239]
buffer_load_dwordx4 v[136:139], v5, s[68:71], s13 offen offset:0 sc1
s_waitcnt vmcnt(7)
v_mfma_f32_16x16x32_bf16 v[252:255], v[188:191], v[140:143], v[252:255]
v_mfma_f32_16x16x32_bf16 v[248:251], v[184:187], v[140:143], v[248:251]
v_mfma_f32_16x16x32_bf16 v[244:247], v[180:183], v[140:143], v[244:247]
v_mfma_f32_16x16x32_bf16 v[240:243], v[176:179], v[140:143], v[240:243]
buffer_load_dwordx4 v[140:143], v5, s[68:71], s13 offen offset:256 sc1
s_waitcnt vmcnt(7) lgkmcnt(8)
v_mfma_f32_16x16x32_bf16 v[192:195], v[160:163], v[144:147], v[192:195]
ds_read_b64_tr_b16 v[176:177], v24 offset:4096
ds_read_b64_tr_b16 v[178:179], v24 offset:4608
v_mfma_f32_16x16x32_bf16 v[196:199], v[164:167], v[144:147], v[196:199]
ds_read_b64_tr_b16 v[180:181], v25 offset:4096
ds_read_b64_tr_b16 v[182:183], v25 offset:4608
v_mfma_f32_16x16x32_bf16 v[200:203], v[168:171], v[144:147], v[200:203]
ds_read_b64_tr_b16 v[184:185], v26 offset:4096
ds_read_b64_tr_b16 v[186:187], v26 offset:4608
v_mfma_f32_16x16x32_bf16 v[204:207], v[172:175], v[144:147], v[204:207]
buffer_load_dwordx4 v[144:147], v4, s[68:71], s14 offen offset:0 sc1
s_waitcnt vmcnt(7)
v_mfma_f32_16x16x32_bf16 v[220:223], v[172:175], v[148:151], v[220:223]
ds_read_b64_tr_b16 v[188:189], v27 offset:4096
ds_read_b64_tr_b16 v[190:191], v27 offset:4608
v_mfma_f32_16x16x32_bf16 v[216:219], v[168:171], v[148:151], v[216:219]
ds_read_b64_tr_b16 v[80:81], v24 offset:0
ds_read_b64_tr_b16 v[82:83], v24 offset:512
v_mfma_f32_16x16x32_bf16 v[212:215], v[164:167], v[148:151], v[212:215]
ds_read_b64_tr_b16 v[84:85], v25 offset:0
ds_read_b64_tr_b16 v[86:87], v25 offset:512
v_mfma_f32_16x16x32_bf16 v[208:211], v[160:163], v[148:151], v[208:211]
buffer_load_dwordx4 v[148:151], v4, s[68:71], s14 offen offset:256 sc1
s_waitcnt vmcnt(7)
v_mfma_f32_16x16x32_bf16 v[224:227], v[160:163], v[152:155], v[224:227]
ds_read_b64_tr_b16 v[88:89], v26 offset:0
ds_read_b64_tr_b16 v[90:91], v26 offset:512
v_mfma_f32_16x16x32_bf16 v[228:231], v[164:167], v[152:155], v[228:231]
ds_read_b64_tr_b16 v[92:93], v27 offset:0
ds_read_b64_tr_b16 v[94:95], v27 offset:512
v_mfma_f32_16x16x32_bf16 v[232:235], v[168:171], v[152:155], v[232:235]
v_mfma_f32_16x16x32_bf16 v[236:239], v[172:175], v[152:155], v[236:239]
buffer_load_dwordx4 v[152:155], v5, s[68:71], s14 offen offset:0 sc1
s_waitcnt vmcnt(7)
v_mfma_f32_16x16x32_bf16 v[252:255], v[172:175], v[156:159], v[252:255]
v_mfma_f32_16x16x32_bf16 v[248:251], v[168:171], v[156:159], v[248:251]
v_mfma_f32_16x16x32_bf16 v[244:247], v[164:167], v[156:159], v[244:247]
v_mfma_f32_16x16x32_bf16 v[240:243], v[160:163], v[156:159], v[240:243]
buffer_load_dwordx4 v[156:159], v5, s[68:71], s14 offen offset:256 sc1
s_waitcnt vmcnt(7) lgkmcnt(8)
v_mfma_f32_16x16x32_bf16 v[192:195], v[176:179], v[128:131], v[192:195]
ds_read_b64_tr_b16 v[160:161], v24 offset:8192
ds_read_b64_tr_b16 v[162:163], v24 offset:8704
v_mfma_f32_16x16x32_bf16 v[196:199], v[180:183], v[128:131], v[196:199]
ds_read_b64_tr_b16 v[164:165], v25 offset:8192
ds_read_b64_tr_b16 v[166:167], v25 offset:8704
v_mfma_f32_16x16x32_bf16 v[200:203], v[184:187], v[128:131], v[200:203]
ds_read_b64_tr_b16 v[168:169], v26 offset:8192
ds_read_b64_tr_b16 v[170:171], v26 offset:8704
v_mfma_f32_16x16x32_bf16 v[204:207], v[188:191], v[128:131], v[204:207]
buffer_load_dwordx4 v[128:131], v5, s[68:71], s8 offen offset:0 sc1
s_waitcnt vmcnt(7)
v_mfma_f32_16x16x32_bf16 v[220:223], v[188:191], v[132:135], v[220:223]
ds_read_b64_tr_b16 v[172:173], v27 offset:8192
ds_read_b64_tr_b16 v[174:175], v27 offset:8704
v_mfma_f32_16x16x32_bf16 v[216:219], v[184:187], v[132:135], v[216:219]
v_mfma_f32_16x16x32_bf16 v[212:215], v[180:183], v[132:135], v[212:215]
v_mfma_f32_16x16x32_bf16 v[208:211], v[176:179], v[132:135], v[208:211]
buffer_load_dwordx4 v[132:135], v5, s[68:71], s9 offen offset:0 sc1
s_waitcnt vmcnt(7)
v_mfma_f32_16x16x32_bf16 v[224:227], v[176:179], v[136:139], v[224:227]
v_med3_f32 v16, v16, s42, -s42
v_med3_f32 v17, v17, s42, -s42
v_mfma_f32_16x16x32_bf16 v[228:231], v[180:183], v[136:139], v[228:231]
v_med3_f32 v18, v18, s42, -s42
v_med3_f32 v19, v19, s42, -s42
v_mfma_f32_16x16x32_bf16 v[232:235], v[184:187], v[136:139], v[232:235]
v_mul_f32 v16, s43, v16
v_mul_f32 v17, s43, v17
v_mfma_f32_16x16x32_bf16 v[236:239], v[188:191], v[136:139], v[236:239]
buffer_load_dwordx4 v[136:139], v5, s[68:71], s8 offen offset:256 sc1
s_waitcnt vmcnt(7)
v_mfma_f32_16x16x32_bf16 v[252:255], v[188:191], v[140:143], v[252:255]
v_mul_f32 v18, s43, v18
v_mul_f32 v19, s43, v19
v_mfma_f32_16x16x32_bf16 v[248:251], v[184:187], v[140:143], v[248:251]
v_exp_f32 v16, v16
v_mfma_f32_16x16x32_bf16 v[244:247], v[180:183], v[140:143], v[244:247]
v_exp_f32 v17, v17
v_mfma_f32_16x16x32_bf16 v[240:243], v[176:179], v[140:143], v[240:243]
buffer_load_dwordx4 v[140:143], v5, s[68:71], s9 offen offset:256 sc1
s_waitcnt vmcnt(7) lgkmcnt(0)
v_mfma_f32_16x16x32_bf16 v[192:195], v[160:163], v[144:147], v[192:195]
v_exp_f32 v18, v18
v_mfma_f32_16x16x32_bf16 v[196:199], v[164:167], v[144:147], v[196:199]
v_exp_f32 v19, v19
v_mfma_f32_16x16x32_bf16 v[200:203], v[168:171], v[144:147], v[200:203]
s_barrier
v_mfma_f32_16x16x32_bf16 v[204:207], v[172:175], v[144:147], v[204:207]
buffer_load_dwordx4 v[144:147], v4, s[68:71], s80 offen offset:0 sc1
s_waitcnt vmcnt(7)
v_mfma_f32_16x16x32_bf16 v[220:223], v[172:175], v[148:151], v[220:223]
v_mfma_f32_16x16x32_bf16 v[216:219], v[168:171], v[148:151], v[216:219]
v_mfma_f32_16x16x32_bf16 v[212:215], v[164:167], v[148:151], v[212:215]
v_mfma_f32_16x16x32_bf16 v[208:211], v[160:163], v[148:151], v[208:211]
buffer_load_dwordx4 v[148:151], v4, s[68:71], s80 offen offset:2048 sc1
s_waitcnt vmcnt(7)
v_mfma_f32_16x16x32_bf16 v[224:227], v[160:163], v[152:155], v[224:227]
v_mfma_f32_16x16x32_bf16 v[228:231], v[164:167], v[152:155], v[228:231]
v_mfma_f32_16x16x32_bf16 v[232:235], v[168:171], v[152:155], v[232:235]
v_mfma_f32_16x16x32_bf16 v[236:239], v[172:175], v[152:155], v[236:239]
buffer_load_dwordx4 v[152:155], v4, s[68:71], s81 offen offset:0 sc1
s_waitcnt vmcnt(7)
v_mfma_f32_16x16x32_bf16 v[252:255], v[172:175], v[156:159], v[252:255]
v_mul_f32 v192, v192, v16
v_mul_f32 v193, v193, v16
v_mfma_f32_16x16x32_bf16 v[248:251], v[168:171], v[156:159], v[248:251]
v_mul_f32 v194, v194, v16
v_mul_f32 v195, v195, v16
v_mfma_f32_16x16x32_bf16 v[244:247], v[164:167], v[156:159], v[244:247]
v_mul_f32 v196, v196, v16
v_mul_f32 v197, v197, v16
v_mfma_f32_16x16x32_bf16 v[240:243], v[160:163], v[156:159], v[240:243]
buffer_load_dwordx4 v[156:159], v4, s[68:71], s81 offen offset:2048 sc1
s_waitcnt vmcnt(7)
v_mfma_f32_16x16x32_bf16 v[224:227], v[96:99], v[128:131], v[224:227]
v_mul_f32 v198, v198, v16
v_mul_f32 v199, v199, v16
v_mfma_f32_16x16x32_bf16 v[228:231], v[100:103], v[128:131], v[228:231]
v_mul_f32 v200, v200, v16
v_mul_f32 v201, v201, v16
v_mfma_f32_16x16x32_bf16 v[232:235], v[104:107], v[128:131], v[232:235]
v_mul_f32 v202, v202, v16
v_mul_f32 v203, v203, v16
v_mfma_f32_16x16x32_bf16 v[236:239], v[108:111], v[128:131], v[236:239]
buffer_load_dwordx4 v[128:131], v4, s[68:71], s80 offen offset:256 sc1
s_waitcnt vmcnt(7)
v_mfma_f32_16x16x32_bf16 v[236:239], v[124:127], v[132:135], v[236:239]
v_mul_f32 v204, v204, v16
v_mul_f32 v205, v205, v16
v_mfma_f32_16x16x32_bf16 v[232:235], v[120:123], v[132:135], v[232:235]
v_mul_f32 v206, v206, v16
v_mul_f32 v207, v207, v16
v_mfma_f32_16x16x32_bf16 v[228:231], v[116:119], v[132:135], v[228:231]
v_mul_f32 v208, v208, v17
v_mul_f32 v209, v209, v17
v_mfma_f32_16x16x32_bf16 v[224:227], v[112:115], v[132:135], v[224:227]
buffer_load_dwordx4 v[132:135], v4, s[68:71], s80 offen offset:2304 sc1
s_waitcnt vmcnt(7)
v_mfma_f32_16x16x32_bf16 v[240:243], v[96:99], v[136:139], v[240:243]
v_mul_f32 v210, v210, v17
v_mul_f32 v211, v211, v17
v_mfma_f32_16x16x32_bf16 v[244:247], v[100:103], v[136:139], v[244:247]
v_mul_f32 v212, v212, v17
v_mul_f32 v213, v213, v17
v_mfma_f32_16x16x32_bf16 v[248:251], v[104:107], v[136:139], v[248:251]
v_mul_f32 v214, v214, v17
v_mul_f32 v215, v215, v17
v_mfma_f32_16x16x32_bf16 v[252:255], v[108:111], v[136:139], v[252:255]
buffer_load_dwordx4 v[136:139], v4, s[68:71], s81 offen offset:256 sc1
s_waitcnt vmcnt(7)
v_mfma_f32_16x16x32_bf16 v[252:255], v[124:127], v[140:143], v[252:255]
v_mul_f32 v216, v216, v17
v_mul_f32 v217, v217, v17
v_mfma_f32_16x16x32_bf16 v[248:251], v[120:123], v[140:143], v[248:251]
v_mul_f32 v218, v218, v17
v_mul_f32 v219, v219, v17
v_mfma_f32_16x16x32_bf16 v[244:247], v[116:119], v[140:143], v[244:247]
v_mul_f32 v220, v220, v17
v_mul_f32 v221, v221, v17
v_mfma_f32_16x16x32_bf16 v[240:243], v[112:115], v[140:143], v[240:243]
buffer_load_dwordx4 v[140:143], v4, s[68:71], s81 offen offset:2304 sc1
s_waitcnt vmcnt(7)
v_mfma_f32_16x16x32_bf16 v[192:195], v[32:35], v[144:147], v[192:195]
v_mul_f32 v222, v222, v17
v_mul_f32 v223, v223, v17
v_mfma_f32_16x16x32_bf16 v[196:199], v[36:39], v[144:147], v[196:199]
v_mul_f32 v224, v224, v18
v_mul_f32 v225, v225, v18
v_mfma_f32_16x16x32_bf16 v[200:203], v[40:43], v[144:147], v[200:203]
v_mul_f32 v226, v226, v18
v_mul_f32 v227, v227, v18
v_mfma_f32_16x16x32_bf16 v[204:207], v[44:47], v[144:147], v[204:207]
buffer_load_dwordx4 v[144:147], v5, s[68:71], s80 offen offset:0 sc1
s_waitcnt vmcnt(7)
v_mfma_f32_16x16x32_bf16 v[204:207], v[60:63], v[148:151], v[204:207]
v_mul_f32 v228, v228, v18
v_mul_f32 v229, v229, v18
v_mfma_f32_16x16x32_bf16 v[200:203], v[56:59], v[148:151], v[200:203]
v_mul_f32 v230, v230, v18
v_mul_f32 v231, v231, v18
v_mfma_f32_16x16x32_bf16 v[196:199], v[52:55], v[148:151], v[196:199]
v_mul_f32 v232, v232, v18
v_mul_f32 v233, v233, v18
v_mfma_f32_16x16x32_bf16 v[192:195], v[48:51], v[148:151], v[192:195]
buffer_load_dwordx4 v[148:151], v5, s[68:71], s80 offen offset:2048 sc1
s_waitcnt vmcnt(7)
v_mfma_f32_16x16x32_bf16 v[192:195], v[64:67], v[152:155], v[192:195]
v_mul_f32 v234, v234, v18
v_mul_f32 v235, v235, v18
v_mfma_f32_16x16x32_bf16 v[196:199], v[68:71], v[152:155], v[196:199]
v_mul_f32 v236, v236, v18
v_mul_f32 v237, v237, v18
v_mfma_f32_16x16x32_bf16 v[200:203], v[72:75], v[152:155], v[200:203]
v_mul_f32 v238, v238, v18
v_mul_f32 v239, v239, v18
v_mfma_f32_16x16x32_bf16 v[204:207], v[76:79], v[152:155], v[204:207]
buffer_load_dwordx4 v[152:155], v5, s[68:71], s81 offen offset:0 sc1
s_waitcnt vmcnt(7)
v_mfma_f32_16x16x32_bf16 v[204:207], v[92:95], v[156:159], v[204:207]
v_mul_f32 v240, v240, v19
v_mul_f32 v241, v241, v19
v_mfma_f32_16x16x32_bf16 v[200:203], v[88:91], v[156:159], v[200:203]
v_mul_f32 v242, v242, v19
v_mul_f32 v243, v243, v19
v_mfma_f32_16x16x32_bf16 v[196:199], v[84:87], v[156:159], v[196:199]
v_mul_f32 v244, v244, v19
v_mul_f32 v245, v245, v19
v_mfma_f32_16x16x32_bf16 v[192:195], v[80:83], v[156:159], v[192:195]
buffer_load_dwordx4 v[156:159], v5, s[68:71], s81 offen offset:2048 sc1
s_waitcnt vmcnt(7)
v_mfma_f32_16x16x32_bf16 v[208:211], v[32:35], v[128:131], v[208:211]
v_mul_f32 v246, v246, v19
v_mul_f32 v247, v247, v19
v_mfma_f32_16x16x32_bf16 v[212:215], v[36:39], v[128:131], v[212:215]
v_mul_f32 v248, v248, v19
v_mul_f32 v249, v249, v19
v_mfma_f32_16x16x32_bf16 v[216:219], v[40:43], v[128:131], v[216:219]
v_mul_f32 v250, v250, v19
v_mul_f32 v251, v251, v19
v_mfma_f32_16x16x32_bf16 v[220:223], v[44:47], v[128:131], v[220:223]
buffer_load_dwordx4 v[128:131], v5, s[68:71], s80 offen offset:256 sc1
s_waitcnt vmcnt(7)
v_mfma_f32_16x16x32_bf16 v[220:223], v[60:63], v[132:135], v[220:223]
v_mul_f32 v252, v252, v19
v_mul_f32 v253, v253, v19
v_mfma_f32_16x16x32_bf16 v[216:219], v[56:59], v[132:135], v[216:219]
v_mul_f32 v254, v254, v19
v_mul_f32 v255, v255, v19
ds_write_b128 v9, v[204:207] offset:40960
v_mfma_f32_16x16x32_bf16 v[212:215], v[52:55], v[132:135], v[212:215]
v_mfma_f32_16x16x32_bf16 v[208:211], v[48:51], v[132:135], v[208:211]
buffer_load_dwordx4 v[132:135], v5, s[68:71], s80 offen offset:2304 sc1
ds_write_b128 v8, v[200:203] offset:40960
s_waitcnt vmcnt(7)
v_mfma_f32_16x16x32_bf16 v[208:211], v[64:67], v[136:139], v[208:211]
v_mfma_f32_16x16x32_bf16 v[212:215], v[68:71], v[136:139], v[212:215]
ds_write_b128 v9, v[196:199] offset:0
v_mfma_f32_16x16x32_bf16 v[216:219], v[72:75], v[136:139], v[216:219]
v_mfma_f32_16x16x32_bf16 v[220:223], v[76:79], v[136:139], v[220:223]
buffer_load_dwordx4 v[136:139], v5, s[68:71], s81 offen offset:256 sc1
ds_write_b128 v8, v[192:195] offset:0
s_waitcnt vmcnt(7)
v_mfma_f32_16x16x32_bf16 v[220:223], v[92:95], v[140:143], v[220:223]
v_mfma_f32_16x16x32_bf16 v[216:219], v[88:91], v[140:143], v[216:219]
v_mfma_f32_16x16x32_bf16 v[212:215], v[84:87], v[140:143], v[212:215]
v_mfma_f32_16x16x32_bf16 v[208:211], v[80:83], v[140:143], v[208:211]
buffer_load_dwordx4 v[140:143], v5, s[68:71], s81 offen offset:2304 sc1
s_waitcnt vmcnt(7)
v_mfma_f32_16x16x32_bf16 v[224:227], v[32:35], v[144:147], v[224:227]
v_mfma_f32_16x16x32_bf16 v[228:231], v[36:39], v[144:147], v[228:231]
v_mfma_f32_16x16x32_bf16 v[232:235], v[40:43], v[144:147], v[232:235]
v_mfma_f32_16x16x32_bf16 v[236:239], v[44:47], v[144:147], v[236:239]
s_waitcnt vmcnt(6)
v_mfma_f32_16x16x32_bf16 v[236:239], v[60:63], v[148:151], v[236:239]
v_mfma_f32_16x16x32_bf16 v[232:235], v[56:59], v[148:151], v[232:235]
ds_write_b128 v9, v[220:223] offset:43008
v_mfma_f32_16x16x32_bf16 v[228:231], v[52:55], v[148:151], v[228:231]
v_mfma_f32_16x16x32_bf16 v[224:227], v[48:51], v[148:151], v[224:227]
ds_write_b128 v8, v[216:219] offset:43008
s_waitcnt vmcnt(5)
v_mfma_f32_16x16x32_bf16 v[224:227], v[64:67], v[152:155], v[224:227]
v_mfma_f32_16x16x32_bf16 v[228:231], v[68:71], v[152:155], v[228:231]
ds_write_b128 v9, v[212:215] offset:2048
v_mfma_f32_16x16x32_bf16 v[232:235], v[72:75], v[152:155], v[232:235]
v_mfma_f32_16x16x32_bf16 v[236:239], v[76:79], v[152:155], v[236:239]
ds_write_b128 v8, v[208:211] offset:2048
s_waitcnt vmcnt(4)
v_mfma_f32_16x16x32_bf16 v[236:239], v[92:95], v[156:159], v[236:239]
v_mfma_f32_16x16x32_bf16 v[232:235], v[88:91], v[156:159], v[232:235]
v_mfma_f32_16x16x32_bf16 v[228:231], v[84:87], v[156:159], v[228:231]
s_waitcnt lgkmcnt(0)
s_barrier
v_mfma_f32_16x16x32_bf16 v[224:227], v[80:83], v[156:159], v[224:227]
s_waitcnt vmcnt(3)
v_mfma_f32_16x16x32_bf16 v[240:243], v[32:35], v[128:131], v[240:243]
v_mfma_f32_16x16x32_bf16 v[244:247], v[36:39], v[128:131], v[244:247]
v_mfma_f32_16x16x32_bf16 v[248:251], v[40:43], v[128:131], v[248:251]
v_mfma_f32_16x16x32_bf16 v[252:255], v[44:47], v[128:131], v[252:255]
s_waitcnt vmcnt(2)
v_mfma_f32_16x16x32_bf16 v[252:255], v[60:63], v[132:135], v[252:255]
v_mfma_f32_16x16x32_bf16 v[248:251], v[56:59], v[132:135], v[248:251]
ds_write_b128 v9, v[236:239] offset:49152
v_mfma_f32_16x16x32_bf16 v[244:247], v[52:55], v[132:135], v[244:247]
v_mfma_f32_16x16x32_bf16 v[240:243], v[48:51], v[132:135], v[240:243]
ds_write_b128 v8, v[232:235] offset:49152
s_waitcnt vmcnt(1)
v_mfma_f32_16x16x32_bf16 v[240:243], v[64:67], v[136:139], v[240:243]
v_mfma_f32_16x16x32_bf16 v[244:247], v[68:71], v[136:139], v[244:247]
ds_write_b128 v9, v[228:231] offset:45056
v_mfma_f32_16x16x32_bf16 v[248:251], v[72:75], v[136:139], v[248:251]
v_mfma_f32_16x16x32_bf16 v[252:255], v[76:79], v[136:139], v[252:255]
ds_write_b128 v8, v[224:227] offset:45056
s_waitcnt vmcnt(0)
v_mfma_f32_16x16x32_bf16 v[252:255], v[92:95], v[140:143], v[252:255]
v_mfma_f32_16x16x32_bf16 v[248:251], v[88:91], v[140:143], v[248:251]
v_mfma_f32_16x16x32_bf16 v[244:247], v[84:87], v[140:143], v[244:247]
v_mfma_f32_16x16x32_bf16 v[240:243], v[80:83], v[140:143], v[240:243]
s_nop 4
ds_write_b128 v9, v[252:255] offset:51200
ds_write_b128 v8, v[248:251] offset:51200
ds_write_b128 v9, v[244:247] offset:47104
ds_write_b128 v8, v[240:243] offset:47104
s_waitcnt lgkmcnt(0)
s_barrier
s_branch L_fin
L_ld_idle:
s_load_dwordx16 s[4:19], s[0:1], 0
s_load_dwordx4 s[20:23], s[0:1], 64
s_load_dwordx2 s[24:25], s[0:1], 80
s_mov_b32 s30, 0
s_waitcnt lgkmcnt(0)
s_and_b32 s38, s2, 6
s_lshr_b32 s39, s2, 5
s_lshl2_add_u32 s34, s38, s39
s_and_b32 s38, s2, 1
s_bfe_u32 s35, s2, 0x20003
s_lshl2_add_u32 s35, s38, s35
s_mov_b32 s72, s16
s_mov_b32 s73, s17
s_mov_b32 s74, 1409024
s_mov_b32 s75, 0x20000
s_mov_b32 s76, s8
s_mov_b32 s77, s9
s_mov_b32 s78, 524288
s_mov_b32 s79, 0x20000
s_mov_b32 s64, s24
s_mov_b32 s65, s25
s_mov_b32 s66, 268435456
s_mov_b32 s67, 0x20000
s_mov_b32 s68, s24
s_mov_b32 s69, s25
s_mov_b32 s70, 7733248
s_mov_b32 s71, 0x20000
s_mov_b32 s84, s22
s_mov_b32 s85, s23
s_mov_b32 s86, 256
s_mov_b32 s87, 0x20000
s_lshl3_add_u32 s38, s34, s35
s_lshl_b32 s38, s38, 8
s_add_u32 s38, s38, 9527296
s_add_u32 s28, s24, s38
s_addc_u32 s29, s25, 0
s_and_b32 s38, s34, 1
s_mul_i32 s36, s38, 6
s_bfe_u32 s38, s34, 0x10001
s_mul_i32 s38, s38, 3
s_add_u32 s36, s36, s38
v_lshrrev_b32 v22, 4, v2
v_and_b32 v23, 15, v2
v_lshlrev_b32 v4, 9, v22
v_lshl_add_u32 v4, v23, 4, v4
v_add_u32 v5, 120832, v4
v_lshlrev_b32 v13, 2, v23
v_lshrrev_b32 v24, 3, v2
v_lshrrev_b32 v25, 2, v2
v_and_b32 v25, 4, v25
v_xor_b32 v25, v25, v2
v_and_b32 v25, 7, v25
s_lshl_b32 s38, s35, 7
v_lshlrev_b32 v6, 10, v24
v_lshl_add_u32 v6, v25, 4, v6
v_add_u32 v6, s38, v6
v_xor_b32 v7, 32, v6
v_add_u32 v7, 7168, v7
v_add_u32 v28, 14336, v6
v_add_u32 v29, 14336, v7
s_mul_i32 s52, s48, 12288
v_bfe_u32 v24, v2, 1, 2
v_and_b32 v25, 1, v2
v_lshl_or_b32 v24, v25, 2, v24
v_xor_b32 v24, v24, v22
s_add_u32 s38, s52, 57344
v_lshlrev_b32 v24, 4, v24
v_lshl_add_u32 v24, v23, 7, v24
v_add_u32 v8, s38, v24
v_xor_b32 v9, 64, v8
v_bfe_u32 v24, v2, 2, 2
v_lshl_add_u32 v25, v22, 3, v24
v_and_b32 v24, 2, v24
v_and_b32 v22, 1, v22
v_or_b32 v24, v24, v22
v_and_b32 v23, 3, v2
v_lshlrev_b32 v25, 7, v25
v_lshl_add_u32 v25, v24, 5, v25
v_lshl_add_u32 v25, v23, 3, v25
v_add_u32 v160, s52, v25
v_xor_b32 v161, 32, v160
v_xor_b32 v162, 64, v160
v_xor_b32 v163, 96, v160
v_add_u32 v24, 49152, v160
v_add_u32 v25, 49152, v161
v_add_u32 v26, 49152, v162
v_add_u32 v27, 49152, v163
s_mul_i32 s53, s34, 241664
v_mov_b32 v22, 0
v_lshlrev_b32 v30, 10, v2
v_lshlrev_b32 v1, 7, v2
s_add_u32 s38, s36, 0
s_cmp_ge_u32 s38, 11
s_cselect_b32 s39, 11, 0
s_sub_u32 s38, s38, s39
s_lshl2_add_u32 s38, s38, s48
s_cmp_ge_u32 s38, 43
s_cselect_b32 s39, 134217728, s53
s_lshl_b32 s38, s38, 11
s_add_u32 s4, s38, s39
s_add_u32 s38, s36, 1
s_cmp_ge_u32 s38, 11
s_cselect_b32 s39, 11, 0
s_sub_u32 s38, s38, s39
s_lshl2_add_u32 s38, s38, s48
s_cmp_ge_u32 s38, 43
s_cselect_b32 s39, 134217728, s53
s_lshl_b32 s38, s38, 11
s_add_u32 s5, s38, s39
s_add_u32 s38, s36, 2
s_cmp_ge_u32 s38, 11
s_cselect_b32 s39, 11, 0
s_sub_u32 s38, s38, s39
s_lshl2_add_u32 s38, s38, s48
s_cmp_ge_u32 s38, 43
s_cselect_b32 s39, 134217728, s53
s_lshl_b32 s38, s38, 11
s_add_u32 s6, s38, s39
s_add_u32 s38, s36, 3
s_cmp_ge_u32 s38, 11
s_cselect_b32 s39, 11, 0
s_sub_u32 s38, s38, s39
s_lshl2_add_u32 s38, s38, s48
s_cmp_ge_u32 s38, 43
s_cselect_b32 s39, 134217728, s53
s_lshl_b32 s38, s38, 11
s_add_u32 s7, s38, s39
s_add_u32 s38, s36, 4
s_cmp_ge_u32 s38, 11
s_cselect_b32 s39, 11, 0
s_sub_u32 s38, s38, s39
s_lshl2_add_u32 s38, s38, s48
s_cmp_ge_u32 s38, 43
s_cselect_b32 s39, 134217728, s53
s_lshl_b32 s38, s38, 11
s_add_u32 s8, s38, s39
s_add_u32 s38, s36, 5
s_cmp_ge_u32 s38, 11
s_cselect_b32 s39, 11, 0
s_sub_u32 s38, s38, s39
s_lshl2_add_u32 s38, s38, s48
s_cmp_ge_u32 s38, 43
s_cselect_b32 s39, 134217728, s53
s_lshl_b32 s38, s38, 11
s_add_u32 s9, s38, s39
s_add_u32 s38, s36, 6
s_cmp_ge_u32 s38, 11
s_cselect_b32 s39, 11, 0
s_sub_u32 s38, s38, s39
s_lshl2_add_u32 s38, s38, s48
s_cmp_ge_u32 s38, 43
s_cselect_b32 s39, 134217728, s53
s_lshl_b32 s38, s38, 11
s_add_u32 s10, s38, s39
s_add_u32 s38, s36, 7
s_cmp_ge_u32 s38, 11
s_cselect_b32 s39, 11, 0
s_sub_u32 s38, s38, s39
s_lshl2_add_u32 s38, s38, s48
s_cmp_ge_u32 s38, 43
s_cselect_b32 s39, 134217728, s53
s_lshl_b32 s38, s38, 11
s_add_u32 s11, s38, s39
s_add_u32 s38, s36, 8
s_cmp_ge_u32 s38, 11
s_cselect_b32 s39, 11, 0
s_sub_u32 s38, s38, s39
s_lshl2_add_u32 s38, s38, s48
s_cmp_ge_u32 s38, 43
s_cselect_b32 s39, 134217728, s53
s_lshl_b32 s38, s38, 11
s_add_u32 s12, s38, s39
s_add_u32 s38, s36, 9
s_cmp_ge_u32 s38, 11
s_cselect_b32 s39, 11, 0
s_sub_u32 s38, s38, s39
s_lshl2_add_u32 s38, s38, s48
s_cmp_ge_u32 s38, 43
s_cselect_b32 s39, 134217728, s53
s_lshl_b32 s38, s38, 11
s_add_u32 s13, s38, s39
s_add_u32 s38, s36, 10
s_cmp_ge_u32 s38, 11
s_cselect_b32 s39, 11, 0
s_sub_u32 s38, s38, s39
s_lshl2_add_u32 s38, s38, s48
s_cmp_ge_u32 s38, 43
s_cselect_b32 s39, 134217728, s53
s_lshl_b32 s38, s38, 11
s_add_u32 s14, s38, s39
s_lshl_b32 s54, s48, 17
s_lshl_b32 s38, s48, 13
s_add_u32 s38, s38, s53
s_add_u32 s80, s38, 88064
s_add_u32 s81, s80, 4096
s_lshl_b32 s44, s34, 8
s_add_u32 s44, s44, 7864320
s_xor_b32 s41, s44, 128
s_mov_b32 s42, 0x42200000
s_mov_b32 s43, 0xbfb8aa3b
s_lshr_b32 s38, s2, 3
s_lshl2_add_u32 s38, s38, s48
s_mul_i32 s38, s38, 11264
s_bitcmp1_b32 s2, 0
s_cselect_b32 s38, 2130706432, s38
s_mov_b32 exec_lo, 0x7ff
s_mov_b32 exec_hi, 0
buffer_load_dword v31, v30, s[72:75], s38 offen offset:384
s_mov_b64 exec, -1
s_barrier
s_mov_b32 s47, 131072
s_mov_b32 exec_lo, 1
s_mov_b32 exec_hi, 0
L_clr2_loop:
buffer_load_dword v23, v22, s[84:87], 0 offen sc1
s_waitcnt vmcnt(0)
v_cmp_gt_u32 vcc, 3, v23
s_nop 0
s_cmp_eq_u64 vcc, 0
s_cbranch_scc1 L_clr2_done
s_sleep 1
s_sub_u32 s47, s47, 1
s_cmp_lg_u32 s47, 0
s_cbranch_scc1 L_clr2_loop
L_clr2_done:
s_mov_b64 exec, -1
s_add_u32 m0, s52, 98304
s_sub_u32 s38, s4, s53
s_lshl_b32 s38, s38, 4
buffer_load_dwordx4 v6, s[72:75], s38 offen offset:0 lds
buffer_load_dwordx4 v7, s[72:75], s38 offen offset:1024 lds
buffer_load_dwordx4 v28, s[72:75], s38 offen offset:2048 lds
buffer_load_dwordx4 v29, s[72:75], s38 offen offset:3072 lds
s_add_u32 m0, s52, 102400
s_sub_u32 s38, s5, s53
s_lshl_b32 s38, s38, 4
buffer_load_dwordx4 v6, s[72:75], s38 offen offset:0 lds
buffer_load_dwordx4 v7, s[72:75], s38 offen offset:1024 lds
buffer_load_dwordx4 v28, s[72:75], s38 offen offset:2048 lds
buffer_load_dwordx4 v29, s[72:75], s38 offen offset:3072 lds
s_add_u32 m0, s52, 106496
s_sub_u32 s38, s6, s53
s_lshl_b32 s38, s38, 4
buffer_load_dwordx4 v6, s[72:75], s38 offen offset:0 lds
buffer_load_dwordx4 v7, s[72:75], s38 offen offset:1024 lds
buffer_load_dwordx4 v28, s[72:75], s38 offen offset:2048 lds
buffer_load_dwordx4 v29, s[72:75], s38 offen offset:3072 lds
s_barrier
s_branch L_ld_tail
L_spec_c:
s_mov_b32 s44, 0xf432aa10
s_mov_b32 s45, 0xff9876a5
s_and_b32 s43, s39, 1
s_lshl1_add_u32 s40, s38, s43
s_lshl_b32 s40, s40, 2
s_lshr_b64 s[44:45], s[44:45], s40
s_and_b32 s27, s44, 15
s_add_u32 s43, s43, 10
s_cmp_eq_u32 s38, 1
s_cselect_b32 s28, s43, 22
s_branch L_cell_c
L_cons:
s_cmp_eq_u32 s26, 0
s_cbranch_scc0 L_nopf
s_getpc_b64 s[40:41]
L_pc:
s_sub_u32 s40, s40, L_pc-gated_mix__linear_attn_block__glu_gated_swiglu__prompt_kernel
s_subb_u32 s41, s41, 0
s_bfe_u32 s42, s2, 0x20003
s_lshl_b32 s42, s42, 13
v_lshl_add_u32 v4, v2, 7, s42
v_min_u32 v4, L_end-gated_mix__linear_attn_block__glu_gated_swiglu__prompt_kernel, v4
global_load_dword v7, v4, s[40:41]
L_nopf:
s_load_dwordx4 s[20:23], s[0:1], 64
s_load_dwordx2 s[24:25], s[0:1], 80
v_mov_b64 v[24:25], 0
v_mov_b64 v[26:27], 0
s_lshr_b32 s39, s2, 3
s_cmp_ge_u32 s39, 30
s_cbranch_scc1 L_spec_c
s_lshl_b32 s42, s38, 1
s_lshr_b32 s41, 0x40a4, s42
s_bitcmp1_b32 0xc3, s38
s_cselect_b32 s43, 5, 6
s_cselect_b32 s44, 13, 11
s_mul_i32 s44, s44, s39
s_lshr_b32 s44, s44, 6
s_mul_i32 s43, s43, s44
s_sub_u32 s43, s39, s43
s_and_b32 s40, s38, 3
s_mul_i32 s40, s40, 5
s_add_u32 s44, s44, s40
s_and_b32 s40, s41, 3
s_add_u32 s28, s44, s40
s_lshr_b32 s40, s38, 2
s_mul_i32 s40, s40, 5
s_add_u32 s27, s40, s43
s_cmp_eq_u32 s43, 5
s_cselect_b32 s27, 10, s27
L_cell_c:
s_mul_i32 s29, s28, 43
s_lshr_b32 s29, s29, 7
s_mul_i32 s40, s29, 3
s_sub_u32 s30, s28, s40
s_sub_u32 s31, s28, s29
s_sub_u32 s31, s31, 1
v_mfma_f32_32x32x16_bf16 v[112:127], v[24:27], v[24:27], 0
v_mov_b32 v6, 156672
v_and_b32 v8, 15, v2
ds_write_b128 v6, v[24:27]
ds_write_b128 v6, v[24:27] offset:16
ds_write_b32 v6, v24 offset:32
v_mfma_f32_32x32x16_bf16 v[128:143], v[24:27], v[24:27], 0
s_lshr_b32 s48, s26, 1
s_and_b32 s49, s26, 1
v_lshrrev_b32 v9, 4, v2
v_mfma_f32_32x32x16_bf16 v[144:159], v[24:27], v[24:27], 0
s_mul_i32 s38, s48, 12288
v_lshl_add_u32 v16, v8, 7, s38
v_mfma_f32_32x32x16_bf16 v[160:175], v[24:27], v[24:27], 0
v_and_b32 v17, 6, v8
v_xor_b32 v17, v17, v9
v_mfma_f32_32x32x16_bf16 v[176:191], v[24:27], v[24:27], 0
v_lshl_add_u32 v10, v17, 4, v16
v_xor_b32 v11, 64, v10
v_mfma_f32_32x32x16_bf16 v[192:207], v[24:27], v[24:27], 0
v_bfe_u32 v17, v2, 2, 2
v_and_b32 v18, 3, v2
v_mfma_f32_32x32x16_bf16 v[208:223], v[24:27], v[24:27], 0
v_lshl_add_u32 v19, v9, 3, v17
v_and_b32 v20, 1, v9
v_mfma_f32_32x32x16_bf16 v[224:239], v[24:27], v[24:27], 0
s_mov_b32 s52, 0
s_mov_b32 s53, 6
v_mfma_f32_32x32x16_bf16 v[240:255], v[24:27], v[24:27], 0
s_waitcnt lgkmcnt(0)
s_cmp_eq_u32 s27, 15
s_cbranch_scc1 L_c_idle
s_cmp_eq_u32 s30, 0
s_cbranch_scc1 L_qkv
s_mul_i32 s38, s49, 96
s_add_u32 s38, s38, 24576
v_mul_u32_u24 v19, 192, v19
v_lshl_add_u32 v19, v18, 3, v19
v_add_u32 v19, s38, v19
s_cmp_eq_u32 s49, 0
s_cselect_b32 s38, 32, -32
v_mul_i32_i24 v20, s38, v20
v_add_u32 v12, v19, v20
v_sub_u32 v13, v19, v20
s_cmp_eq_u32 s31, 14
s_cselect_b32 s38, s49, 0
s_cmp_eq_u32 s38, 1
s_cbranch_scc1 L_gate
L_pad1:
s_cbranch_scc1 L_cons
s_mul_i32 s38, s27, 6
s_mul_i32 s39, s48, 3
s_add_u32 s50, s38, s39
v_lshlrev_b32 v14, 4, v2
v_lshlrev_b32 v15, 2, v2
s_mov_b32 s64, s24
s_mov_b32 s65, s25
s_mov_b32 s66, 268435456
s_mov_b32 s67, 0x20000
s_mov_b32 s68, s24
s_mov_b32 s69, s25
s_mov_b32 s70, 7733248
s_mov_b32 s71, 0x20000
s_cmp_eq_u32 s27, 10
s_mov_b32 s15, 0xffffff
s_cselect_b32 s15, 0xffff, s15
s_mul_i32 s51, s27, 48
s_lshr_b32 s38, s31, 3
s_add_u32 s51, s51, s38
s_lshl_b32 s51, s51, 5
s_and_b32 s38, s31, 7
s_add_u32 s51, s51, s38
s_lshl2_add_u32 s51, s51, 9527296
v_lshlrev_b32 v0, 8, v2
s_mul_i32 s38, s31, 6
s_mul_i32 s39, s49, 3
s_add_u32 s38, s38, s39
s_mul_i32 s39, s50, 118
s_add_u32 s39, s39, s38
s_lshl_b32 s4, s39, 10
s_cmp_lt_u32 s38, 84
s_cselect_b32 s7, s4, 2130706432
s_add_u32 s5, s4, 120832
s_add_u32 s8, s7, 120832
s_add_u32 s6, s4, 241664
s_add_u32 s9, s7, 241664
s_mov_b32 s44, 0xbfb8aa3b
s_mov_b32 s45, 0xbfb8aa3b
s_barrier
s_nop 0
ds_read_b64_tr_b16 v[40:41], v12 offset:0
ds_read_b64_tr_b16 v[42:43], v12 offset:768
ds_read_b128 v[16:19], v10 offset:0
ds_read_b128 v[20:23], v10 offset:2048
ds_read_b128 v[24:27], v10 offset:4096
ds_read_b128 v[28:31], v10 offset:6144
ds_read_b128 v[32:35], v10 offset:8192
ds_read_b128 v[36:39], v10 offset:10240
ds_read_b64_tr_b16 v[44:45], v13 offset:32
ds_read_b64_tr_b16 v[46:47], v13 offset:800
ds_read_b64_tr_b16 v[48:49], v12 offset:64
ds_read_b64_tr_b16 v[50:51], v12 offset:832
ds_read_b64_tr_b16 v[52:53], v12 offset:12288
ds_read_b64_tr_b16 v[54:55], v12 offset:13056
ds_read_b64_tr_b16 v[56:57], v13 offset:12320
ds_read_b64_tr_b16 v[58:59], v13 offset:13088
ds_read_b64_tr_b16 v[60:61], v12 offset:12352
ds_read_b64_tr_b16 v[62:63], v12 offset:13120
s_waitcnt lgkmcnt(0)
s_nop 0
L_loop_w13:
v_mfma_f32_16x16x32_bf16 v[112:115], v[40:43], v[16:19], v[112:115]
ds_read_b64_tr_b16 v[88:89], v12 offset:6144
v_mfma_f32_16x16x32_bf16 v[136:139], v[40:43], v[20:23], v[136:139]
ds_read_b64_tr_b16 v[90:91], v12 offset:6912
v_mfma_f32_16x16x32_bf16 v[160:163], v[40:43], v[24:27], v[160:163]
ds_read_b128 v[64:67], v11 offset:0
v_mfma_f32_16x16x32_bf16 v[184:187], v[40:43], v[28:31], v[184:187]
ds_read_b128 v[68:71], v11 offset:2048
v_mfma_f32_16x16x32_bf16 v[208:211], v[40:43], v[32:35], v[208:211]
ds_read_b128 v[72:75], v11 offset:4096
v_mfma_f32_16x16x32_bf16 v[232:235], v[40:43], v[36:39], v[232:235]
ds_read_b128 v[76:79], v11 offset:6144
v_mfma_f32_16x16x32_bf16 v[236:239], v[44:47], v[36:39], v[236:239]
ds_read_b128 v[80:83], v11 offset:8192
v_mfma_f32_16x16x32_bf16 v[212:215], v[44:47], v[32:35], v[212:215]
ds_read_b128 v[84:87], v11 offset:10240
v_mfma_f32_16x16x32_bf16 v[188:191], v[44:47], v[28:31], v[188:191]
ds_read_b64_tr_b16 v[92:93], v13 offset:6176
v_mfma_f32_16x16x32_bf16 v[164:167], v[44:47], v[24:27], v[164:167]
ds_read_b64_tr_b16 v[94:95], v13 offset:6944
v_mfma_f32_16x16x32_bf16 v[140:143], v[44:47], v[20:23], v[140:143]
ds_read_b64_tr_b16 v[96:97], v12 offset:6208
v_mfma_f32_16x16x32_bf16 v[116:119], v[44:47], v[16:19], v[116:119]
ds_read_b64_tr_b16 v[98:99], v12 offset:6976
v_mfma_f32_16x16x32_bf16 v[120:123], v[48:51], v[16:19], v[120:123]
ds_read_b64_tr_b16 v[100:101], v12 offset:18432
v_mfma_f32_16x16x32_bf16 v[144:147], v[48:51], v[20:23], v[144:147]
ds_read_b64_tr_b16 v[102:103], v12 offset:19200
v_mfma_f32_16x16x32_bf16 v[168:171], v[48:51], v[24:27], v[168:171]
ds_read_b64_tr_b16 v[104:105], v13 offset:18464
v_mfma_f32_16x16x32_bf16 v[192:195], v[48:51], v[28:31], v[192:195]
ds_read_b64_tr_b16 v[106:107], v13 offset:19232
v_mfma_f32_16x16x32_bf16 v[216:219], v[48:51], v[32:35], v[216:219]
ds_read_b64_tr_b16 v[108:109], v12 offset:18496
v_mfma_f32_16x16x32_bf16 v[240:243], v[48:51], v[36:39], v[240:243]
ds_read_b64_tr_b16 v[110:111], v12 offset:19264
v_mfma_f32_16x16x32_bf16 v[244:247], v[52:55], v[36:39], v[244:247]
s_add_u32 s52, s52, 1
s_cmp_eq_u32 s52, 3
v_mfma_f32_16x16x32_bf16 v[220:223], v[52:55], v[32:35], v[220:223]
s_mov_b32 s54, 49152
v_mfma_f32_16x16x32_bf16 v[196:199], v[52:55], v[28:31], v[196:199]
s_cselect_b32 s54, -98304, s54
v_mfma_f32_16x16x32_bf16 v[172:175], v[52:55], v[24:27], v[172:175]
v_add_u32 v10, s54, v10
v_add_u32 v11, s54, v11
v_mfma_f32_16x16x32_bf16 v[148:151], v[52:55], v[20:23], v[148:151]
v_add_u32 v12, s54, v12
v_add_u32 v13, s54, v13
v_mfma_f32_16x16x32_bf16 v[124:127], v[52:55], v[16:19], v[124:127]
v_mfma_f32_16x16x32_bf16 v[128:131], v[56:59], v[16:19], v[128:131]
v_mfma_f32_16x16x32_bf16 v[152:155], v[56:59], v[20:23], v[152:155]
v_mfma_f32_16x16x32_bf16 v[176:179], v[56:59], v[24:27], v[176:179]
v_mfma_f32_16x16x32_bf16 v[200:203], v[56:59], v[28:31], v[200:203]
v_mfma_f32_16x16x32_bf16 v[224:227], v[56:59], v[32:35], v[224:227]
v_mfma_f32_16x16x32_bf16 v[248:251], v[56:59], v[36:39], v[248:251]
v_mfma_f32_16x16x32_bf16 v[252:255], v[60:63], v[36:39], v[252:255]
v_mfma_f32_16x16x32_bf16 v[228:231], v[60:63], v[32:35], v[228:231]
v_mfma_f32_16x16x32_bf16 v[204:207], v[60:63], v[28:31], v[204:207]
v_mfma_f32_16x16x32_bf16 v[180:183], v[60:63], v[24:27], v[180:183]
v_mfma_f32_16x16x32_bf16 v[156:159], v[60:63], v[20:23], v[156:159]
v_mfma_f32_16x16x32_bf16 v[132:135], v[60:63], v[16:19], v[132:135]
s_waitcnt lgkmcnt(0)
s_cselect_b32 s52, 0, s52
v_mfma_f32_16x16x32_bf16 v[112:115], v[88:91], v[64:67], v[112:115]
v_mfma_f32_16x16x32_bf16 v[136:139], v[88:91], v[68:71], v[136:139]
v_mfma_f32_16x16x32_bf16 v[160:163], v[88:91], v[72:75], v[160:163]
v_mfma_f32_16x16x32_bf16 v[184:187], v[88:91], v[76:79], v[184:187]
v_mfma_f32_16x16x32_bf16 v[208:211], v[88:91], v[80:83], v[208:211]
v_mfma_f32_16x16x32_bf16 v[232:235], v[88:91], v[84:87], v[232:235]
v_mfma_f32_16x16x32_bf16 v[236:239], v[92:95], v[84:87], v[236:239]
v_mfma_f32_16x16x32_bf16 v[212:215], v[92:95], v[80:83], v[212:215]
v_mfma_f32_16x16x32_bf16 v[188:191], v[92:95], v[76:79], v[188:191]
v_mfma_f32_16x16x32_bf16 v[164:167], v[92:95], v[72:75], v[164:167]
v_mfma_f32_16x16x32_bf16 v[140:143], v[92:95], v[68:71], v[140:143]
s_barrier
s_sub_u32 s53, s53, 1
v_mfma_f32_16x16x32_bf16 v[116:119], v[92:95], v[64:67], v[116:119]
ds_read_b64_tr_b16 v[40:41], v12 offset:0
v_mfma_f32_16x16x32_bf16 v[120:123], v[96:99], v[64:67], v[120:123]
ds_read_b64_tr_b16 v[42:43], v12 offset:768
v_mfma_f32_16x16x32_bf16 v[144:147], v[96:99], v[68:71], v[144:147]
ds_read_b128 v[16:19], v10 offset:0
v_mfma_f32_16x16x32_bf16 v[168:171], v[96:99], v[72:75], v[168:171]
ds_read_b128 v[20:23], v10 offset:2048
v_mfma_f32_16x16x32_bf16 v[192:195], v[96:99], v[76:79], v[192:195]
ds_read_b128 v[24:27], v10 offset:4096
v_mfma_f32_16x16x32_bf16 v[216:219], v[96:99], v[80:83], v[216:219]
ds_read_b128 v[28:31], v10 offset:6144
v_mfma_f32_16x16x32_bf16 v[240:243], v[96:99], v[84:87], v[240:243]
ds_read_b128 v[32:35], v10 offset:8192
v_mfma_f32_16x16x32_bf16 v[244:247], v[100:103], v[84:87], v[244:247]
ds_read_b128 v[36:39], v10 offset:10240
v_mfma_f32_16x16x32_bf16 v[220:223], v[100:103], v[80:83], v[220:223]
ds_read_b64_tr_b16 v[44:45], v13 offset:32
v_mfma_f32_16x16x32_bf16 v[196:199], v[100:103], v[76:79], v[196:199]
ds_read_b64_tr_b16 v[46:47], v13 offset:800
v_mfma_f32_16x16x32_bf16 v[172:175], v[100:103], v[72:75], v[172:175]
ds_read_b64_tr_b16 v[48:49], v12 offset:64
v_mfma_f32_16x16x32_bf16 v[148:151], v[100:103], v[68:71], v[148:151]
ds_read_b64_tr_b16 v[50:51], v12 offset:832
v_mfma_f32_16x16x32_bf16 v[124:127], v[100:103], v[64:67], v[124:127]
ds_read_b64_tr_b16 v[52:53], v12 offset:12288
v_mfma_f32_16x16x32_bf16 v[128:131], v[104:107], v[64:67], v[128:131]
ds_read_b64_tr_b16 v[54:55], v12 offset:13056
v_mfma_f32_16x16x32_bf16 v[152:155], v[104:107], v[68:71], v[152:155]
ds_read_b64_tr_b16 v[56:57], v13 offset:12320
v_mfma_f32_16x16x32_bf16 v[176:179], v[104:107], v[72:75], v[176:179]
ds_read_b64_tr_b16 v[58:59], v13 offset:13088
v_mfma_f32_16x16x32_bf16 v[200:203], v[104:107], v[76:79], v[200:203]
ds_read_b64_tr_b16 v[60:61], v12 offset:12352
v_mfma_f32_16x16x32_bf16 v[224:227], v[104:107], v[80:83], v[224:227]
ds_read_b64_tr_b16 v[62:63], v12 offset:13120
v_mfma_f32_16x16x32_bf16 v[248:251], v[104:107], v[84:87], v[248:251]
v_mfma_f32_16x16x32_bf16 v[252:255], v[108:111], v[84:87], v[252:255]
v_mfma_f32_16x16x32_bf16 v[228:231], v[108:111], v[80:83], v[228:231]
v_mfma_f32_16x16x32_bf16 v[204:207], v[108:111], v[76:79], v[204:207]
v_mfma_f32_16x16x32_bf16 v[180:183], v[108:111], v[72:75], v[180:183]
v_mfma_f32_16x16x32_bf16 v[156:159], v[108:111], v[68:71], v[156:159]
v_mfma_f32_16x16x32_bf16 v[132:135], v[108:111], v[64:67], v[132:135]
s_waitcnt lgkmcnt(0)
s_cbranch_scc0 L_loop_w13
v_mfma_f32_16x16x32_bf16 v[112:115], v[40:43], v[16:19], v[112:115]
ds_read_b128 v[64:67], v11 offset:0
ds_read_b128 v[68:71], v11 offset:2048
v_mfma_f32_16x16x32_bf16 v[136:139], v[40:43], v[20:23], v[136:139]
ds_read_b64_tr_b16 v[88:89], v12 offset:6144
ds_read_b64_tr_b16 v[90:91], v12 offset:6912
v_mfma_f32_16x16x32_bf16 v[160:163], v[40:43], v[24:27], v[160:163]
ds_read_b64_tr_b16 v[100:101], v12 offset:18432
ds_read_b64_tr_b16 v[102:103], v12 offset:19200
v_mfma_f32_16x16x32_bf16 v[184:187], v[40:43], v[28:31], v[184:187]
ds_read_b128 v[72:75], v11 offset:4096
ds_read_b128 v[76:79], v11 offset:6144
v_mfma_f32_16x16x32_bf16 v[208:211], v[40:43], v[32:35], v[208:211]
ds_read_b128 v[80:83], v11 offset:8192
ds_read_b128 v[84:87], v11 offset:10240
v_mfma_f32_16x16x32_bf16 v[232:235], v[40:43], v[36:39], v[232:235]
ds_read_b64_tr_b16 v[92:93], v13 offset:6176
ds_read_b64_tr_b16 v[94:95], v13 offset:6944
v_mfma_f32_16x16x32_bf16 v[244:247], v[52:55], v[36:39], v[244:247]
ds_read_b64_tr_b16 v[104:105], v13 offset:18464
ds_read_b64_tr_b16 v[106:107], v13 offset:19232
v_mfma_f32_16x16x32_bf16 v[220:223], v[52:55], v[32:35], v[220:223]
ds_read_b64_tr_b16 v[96:97], v12 offset:6208
ds_read_b64_tr_b16 v[98:99], v12 offset:6976
v_mfma_f32_16x16x32_bf16 v[196:199], v[52:55], v[28:31], v[196:199]
ds_read_b64_tr_b16 v[108:109], v12 offset:18496
ds_read_b64_tr_b16 v[110:111], v12 offset:19264
v_mfma_f32_16x16x32_bf16 v[172:175], v[52:55], v[24:27], v[172:175]
v_mfma_f32_16x16x32_bf16 v[148:151], v[52:55], v[20:23], v[148:151]
v_mfma_f32_16x16x32_bf16 v[124:127], v[52:55], v[16:19], v[124:127]
s_waitcnt lgkmcnt(8)
s_nop 0
v_mfma_f32_16x16x32_bf16 v[112:115], v[88:91], v[64:67], v[112:115]
s_nop 0
s_nop 0
v_mfma_f32_16x16x32_bf16 v[136:139], v[88:91], v[68:71], v[136:139]
s_nop 0
s_nop 0
v_mfma_f32_16x16x32_bf16 v[124:127], v[100:103], v[64:67], v[124:127]
s_nop 0
s_waitcnt lgkmcnt(0)
v_mfma_f32_16x16x32_bf16 v[148:151], v[100:103], v[68:71], v[148:151]
v_mul_f32 v40, s44, v112
v_mul_f32 v41, s44, v113
v_mfma_f32_16x16x32_bf16 v[160:163], v[88:91], v[72:75], v[160:163]
v_mul_f32 v42, s44, v114
v_mul_f32 v43, s44, v115
v_mfma_f32_16x16x32_bf16 v[184:187], v[88:91], v[76:79], v[184:187]
v_mul_f32 v52, s44, v136
v_mul_f32 v53, s44, v137
v_mfma_f32_16x16x32_bf16 v[172:175], v[100:103], v[72:75], v[172:175]
v_mul_f32 v54, s44, v138
v_mul_f32 v55, s44, v139
v_mfma_f32_16x16x32_bf16 v[196:199], v[100:103], v[76:79], v[196:199]
v_exp_f32_e64 v40, v40
v_mfma_f32_16x16x32_bf16 v[208:211], v[88:91], v[80:83], v[208:211]
v_exp_f32_e64 v41, v41
v_mfma_f32_16x16x32_bf16 v[232:235], v[88:91], v[84:87], v[232:235]
v_exp_f32_e64 v42, v42
v_mfma_f32_16x16x32_bf16 v[220:223], v[100:103], v[80:83], v[220:223]
v_exp_f32_e64 v43, v43
v_mfma_f32_16x16x32_bf16 v[244:247], v[100:103], v[84:87], v[244:247]
v_exp_f32_e64 v52, v52
v_mfma_f32_16x16x32_bf16 v[116:119], v[44:47], v[16:19], v[116:119]
v_exp_f32_e64 v53, v53
v_mfma_f32_16x16x32_bf16 v[140:143], v[44:47], v[20:23], v[140:143]
v_exp_f32_e64 v54, v54
v_mfma_f32_16x16x32_bf16 v[164:167], v[44:47], v[24:27], v[164:167]
v_exp_f32_e64 v55, v55
v_mfma_f32_16x16x32_bf16 v[188:191], v[44:47], v[28:31], v[188:191]
v_add_f32 v40, 1.0, v40
v_add_f32 v41, 1.0, v41
v_mfma_f32_16x16x32_bf16 v[212:215], v[44:47], v[32:35], v[212:215]
v_add_f32 v42, 1.0, v42
v_add_f32 v43, 1.0, v43
v_mfma_f32_16x16x32_bf16 v[236:239], v[44:47], v[36:39], v[236:239]
v_add_f32 v52, 1.0, v52
v_add_f32 v53, 1.0, v53
v_mfma_f32_16x16x32_bf16 v[248:251], v[56:59], v[36:39], v[248:251]
v_add_f32 v54, 1.0, v54
v_add_f32 v55, 1.0, v55
v_mfma_f32_16x16x32_bf16 v[224:227], v[56:59], v[32:35], v[224:227]
v_rcp_f32_e64 v40, v40
v_mfma_f32_16x16x32_bf16 v[200:203], v[56:59], v[28:31], v[200:203]
v_rcp_f32_e64 v41, v41
v_mfma_f32_16x16x32_bf16 v[176:179], v[56:59], v[24:27], v[176:179]
v_rcp_f32_e64 v42, v42
v_mfma_f32_16x16x32_bf16 v[152:155], v[56:59], v[20:23], v[152:155]
v_rcp_f32_e64 v43, v43
v_mfma_f32_16x16x32_bf16 v[128:131], v[56:59], v[16:19], v[128:131]
v_rcp_f32_e64 v52, v52
v_mfma_f32_16x16x32_bf16 v[116:119], v[92:95], v[64:67], v[116:119]
v_rcp_f32_e64 v53, v53
v_mfma_f32_16x16x32_bf16 v[140:143], v[92:95], v[68:71], v[140:143]
v_rcp_f32_e64 v54, v54
v_mfma_f32_16x16x32_bf16 v[164:167], v[92:95], v[72:75], v[164:167]
v_rcp_f32_e64 v55, v55
v_mfma_f32_16x16x32_bf16 v[188:191], v[92:95], v[76:79], v[188:191]
v_mul_f32 v88, s44, v160
v_mul_f32 v89, s44, v161
v_mfma_f32_16x16x32_bf16 v[212:215], v[92:95], v[80:83], v[212:215]
v_mul_f32 v90, s44, v162
v_mul_f32 v91, s44, v163
v_mfma_f32_16x16x32_bf16 v[236:239], v[92:95], v[84:87], v[236:239]
v_mul_f32 v100, s44, v184
v_mul_f32 v101, s44, v185
v_mfma_f32_16x16x32_bf16 v[248:251], v[104:107], v[84:87], v[248:251]
v_mul_f32 v102, s44, v186
v_mul_f32 v103, s44, v187
v_mfma_f32_16x16x32_bf16 v[224:227], v[104:107], v[80:83], v[224:227]
v_exp_f32_e64 v88, v88
v_mfma_f32_16x16x32_bf16 v[200:203], v[104:107], v[76:79], v[200:203]
v_exp_f32_e64 v89, v89
v_mfma_f32_16x16x32_bf16 v[176:179], v[104:107], v[72:75], v[176:179]
v_exp_f32_e64 v90, v90
v_mfma_f32_16x16x32_bf16 v[152:155], v[104:107], v[68:71], v[152:155]
v_exp_f32_e64 v91, v91
v_mfma_f32_16x16x32_bf16 v[128:131], v[104:107], v[64:67], v[128:131]
v_exp_f32_e64 v100, v100
v_mfma_f32_16x16x32_bf16 v[120:123], v[48:51], v[16:19], v[120:123]
v_exp_f32_e64 v101, v101
v_mfma_f32_16x16x32_bf16 v[144:147], v[48:51], v[20:23], v[144:147]
v_exp_f32_e64 v102, v102
v_mfma_f32_16x16x32_bf16 v[168:171], v[48:51], v[24:27], v[168:171]
v_exp_f32_e64 v103, v103
v_mfma_f32_16x16x32_bf16 v[192:195], v[48:51], v[28:31], v[192:195]
v_add_f32 v88, 1.0, v88
v_add_f32 v89, 1.0, v89
v_mfma_f32_16x16x32_bf16 v[216:219], v[48:51], v[32:35], v[216:219]
v_add_f32 v90, 1.0, v90
v_add_f32 v91, 1.0, v91
v_mfma_f32_16x16x32_bf16 v[240:243], v[48:51], v[36:39], v[240:243]
v_add_f32 v100, 1.0, v100
v_add_f32 v101, 1.0, v101
v_mfma_f32_16x16x32_bf16 v[252:255], v[60:63], v[36:39], v[252:255]
v_add_f32 v102, 1.0, v102
v_add_f32 v103, 1.0, v103
v_mfma_f32_16x16x32_bf16 v[228:231], v[60:63], v[32:35], v[228:231]
v_rcp_f32_e64 v88, v88
v_mfma_f32_16x16x32_bf16 v[204:207], v[60:63], v[28:31], v[204:207]
v_rcp_f32_e64 v89, v89
v_mfma_f32_16x16x32_bf16 v[180:183], v[60:63], v[24:27], v[180:183]
v_rcp_f32_e64 v90, v90
v_mfma_f32_16x16x32_bf16 v[156:159], v[60:63], v[20:23], v[156:159]
v_rcp_f32_e64 v91, v91
v_mfma_f32_16x16x32_bf16 v[132:135], v[60:63], v[16:19], v[132:135]
v_rcp_f32_e64 v100, v100
v_mfma_f32_16x16x32_bf16 v[120:123], v[96:99], v[64:67], v[120:123]
v_rcp_f32_e64 v101, v101
v_mfma_f32_16x16x32_bf16 v[144:147], v[96:99], v[68:71], v[144:147]
v_rcp_f32_e64 v102, v102
v_mfma_f32_16x16x32_bf16 v[168:171], v[96:99], v[72:75], v[168:171]
v_rcp_f32_e64 v103, v103
v_mfma_f32_16x16x32_bf16 v[192:195], v[96:99], v[76:79], v[192:195]
v_mul_f32 v44, s44, v208
v_mul_f32 v45, s44, v209
v_mfma_f32_16x16x32_bf16 v[216:219], v[96:99], v[80:83], v[216:219]
v_mul_f32 v46, s44, v210
v_mul_f32 v47, s44, v211
v_mfma_f32_16x16x32_bf16 v[240:243], v[96:99], v[84:87], v[240:243]
v_mul_f32 v56, s44, v232
v_mul_f32 v57, s44, v233
v_mfma_f32_16x16x32_bf16 v[252:255], v[108:111], v[84:87], v[252:255]
v_mul_f32 v58, s44, v234
v_mul_f32 v59, s44, v235
v_mfma_f32_16x16x32_bf16 v[228:231], v[108:111], v[80:83], v[228:231]
v_exp_f32_e64 v44, v44
v_mfma_f32_16x16x32_bf16 v[204:207], v[108:111], v[76:79], v[204:207]
v_exp_f32_e64 v45, v45
v_mfma_f32_16x16x32_bf16 v[180:183], v[108:111], v[72:75], v[180:183]
v_exp_f32_e64 v46, v46
v_mfma_f32_16x16x32_bf16 v[156:159], v[108:111], v[68:71], v[156:159]
v_exp_f32_e64 v47, v47
v_mfma_f32_16x16x32_bf16 v[132:135], v[108:111], v[64:67], v[132:135]
v_exp_f32_e64 v56, v56
v_pk_mul_f32 v[124:125], v[112:113], v[124:125]
v_pk_mul_f32 v[126:127], v[114:115], v[126:127]
v_pk_mul_f32 v[148:149], v[136:137], v[148:149]
v_pk_mul_f32 v[150:151], v[138:139], v[150:151]
v_pk_mul_f32 v[112:113], v[124:125], v[40:41]
v_pk_mul_f32 v[114:115], v[126:127], v[42:43]
v_pk_mul_f32 v[136:137], v[148:149], v[52:53]
v_pk_mul_f32 v[138:139], v[150:151], v[54:55]
v_cvt_pk_bf16_f32 v64, v112, v113
v_cvt_pk_bf16_f32 v65, v114, v115
v_cvt_pk_bf16_f32 v66, v136, v137
v_cvt_pk_bf16_f32 v67, v138, v139
v_pk_mul_f32 v[172:173], v[160:161], v[172:173]
v_pk_mul_f32 v[174:175], v[162:163], v[174:175]
v_pk_mul_f32 v[196:197], v[184:185], v[196:197]
v_pk_mul_f32 v[198:199], v[186:187], v[198:199]
v_permlane16_swap_b32 v64, v66
v_permlane16_swap_b32 v65, v67
buffer_store_dwordx4 v[64:67], v14, s[68:71], s4 offen offset:0 sc1
v_pk_mul_f32 v[160:161], v[172:173], v[88:89]
v_pk_mul_f32 v[162:163], v[174:175], v[90:91]
v_pk_mul_f32 v[184:185], v[196:197], v[100:101]
v_pk_mul_f32 v[186:187], v[198:199], v[102:103]
v_cvt_pk_bf16_f32 v68, v160, v161
v_cvt_pk_bf16_f32 v69, v162, v163
v_cvt_pk_bf16_f32 v70, v184, v185
v_cvt_pk_bf16_f32 v71, v186, v187
v_pk_mul_f32 v[220:221], v[208:209], v[220:221]
v_pk_mul_f32 v[222:223], v[210:211], v[222:223]
v_pk_mul_f32 v[244:245], v[232:233], v[244:245]
v_pk_mul_f32 v[246:247], v[234:235], v[246:247]
v_permlane16_swap_b32 v68, v70
v_permlane16_swap_b32 v69, v71
buffer_store_dwordx4 v[68:71], v14, s[68:71], s5 offen offset:0 sc1
v_exp_f32 v57, v57
v_exp_f32 v58, v58
v_exp_f32_e64 v59, v59
v_pk_add_f32 v[44:45], v[44:45], 1.0 op_sel_hi:[1,0]
v_pk_add_f32 v[46:47], v[46:47], 1.0 op_sel_hi:[1,0]
v_pk_add_f32 v[56:57], v[56:57], 1.0 op_sel_hi:[1,0]
v_pk_add_f32 v[58:59], v[58:59], 1.0 op_sel_hi:[1,0]
v_rcp_f32 v44, v44
v_rcp_f32 v45, v45
v_rcp_f32 v46, v46
v_rcp_f32 v47, v47
v_rcp_f32 v56, v56
v_rcp_f32 v57, v57
v_rcp_f32 v58, v58
v_rcp_f32 v59, v59
v_pk_mul_f32 v[208:209], v[220:221], v[44:45]
v_pk_mul_f32 v[210:211], v[222:223], v[46:47]
v_pk_mul_f32 v[232:233], v[244:245], v[56:57]
v_pk_mul_f32 v[234:235], v[246:247], v[58:59]
v_cvt_pk_bf16_f32 v72, v208, v209
v_cvt_pk_bf16_f32 v73, v210, v211
v_cvt_pk_bf16_f32 v74, v232, v233
v_cvt_pk_bf16_f32 v75, v234, v235
v_pk_mul_f32 v[128:129], v[116:117], v[128:129]
v_pk_mul_f32 v[130:131], v[118:119], v[130:131]
v_pk_mul_f32 v[152:153], v[140:141], v[152:153]
v_pk_mul_f32 v[154:155], v[142:143], v[154:155]
v_permlane16_swap_b32 v72, v74
v_permlane16_swap_b32 v73, v75
buffer_store_dwordx4 v[72:75], v14, s[68:71], s6 offen offset:0 sc1
v_pk_mul_f32 v[24:25], v[116:117], s[44:45]
v_pk_mul_f32 v[26:27], v[118:119], s[44:45]
v_pk_mul_f32 v[28:29], v[140:141], s[44:45]
v_pk_mul_f32 v[30:31], v[142:143], s[44:45]
v_exp_f32 v24, v24
v_exp_f32 v25, v25
v_exp_f32 v26, v26
v_exp_f32 v27, v27
v_exp_f32 v28, v28
v_exp_f32 v29, v29
v_exp_f32 v30, v30
v_exp_f32 v31, v31
v_pk_add_f32 v[24:25], v[24:25], 1.0 op_sel_hi:[1,0]
v_pk_add_f32 v[26:27], v[26:27], 1.0 op_sel_hi:[1,0]
v_pk_add_f32 v[28:29], v[28:29], 1.0 op_sel_hi:[1,0]
v_pk_add_f32 v[30:31], v[30:31], 1.0 op_sel_hi:[1,0]
v_rcp_f32 v24, v24
v_rcp_f32 v25, v25
v_rcp_f32 v26, v26
v_rcp_f32 v27, v27
v_rcp_f32 v28, v28
v_rcp_f32 v29, v29
v_rcp_f32 v30, v30
v_rcp_f32 v31, v31
v_pk_mul_f32 v[116:117], v[128:129], v[24:25]
v_pk_mul_f32 v[118:119], v[130:131], v[26:27]
v_pk_mul_f32 v[140:141], v[152:153], v[28:29]
v_pk_mul_f32 v[142:143], v[154:155], v[30:31]
v_cvt_pk_bf16_f32 v76, v116, v117
v_cvt_pk_bf16_f32 v77, v118, v119
v_cvt_pk_bf16_f32 v78, v140, v141
v_cvt_pk_bf16_f32 v79, v142, v143
v_pk_mul_f32 v[176:177], v[164:165], v[176:177]
v_pk_mul_f32 v[178:179], v[166:167], v[178:179]
v_pk_mul_f32 v[200:201], v[188:189], v[200:201]
v_pk_mul_f32 v[202:203], v[190:191], v[202:203]
v_permlane16_swap_b32 v76, v78
v_permlane16_swap_b32 v77, v79
buffer_store_dwordx4 v[76:79], v14, s[68:71], s4 offen offset:1024 sc1
v_pk_mul_f32 v[16:17], v[164:165], s[44:45]
v_pk_mul_f32 v[18:19], v[166:167], s[44:45]
v_pk_mul_f32 v[20:21], v[188:189], s[44:45]
v_pk_mul_f32 v[22:23], v[190:191], s[44:45]
v_exp_f32 v16, v16
v_exp_f32 v17, v17
v_exp_f32 v18, v18
v_exp_f32 v19, v19
v_exp_f32 v20, v20
v_exp_f32 v21, v21
v_exp_f32 v22, v22
v_exp_f32 v23, v23
v_pk_add_f32 v[16:17], v[16:17], 1.0 op_sel_hi:[1,0]
v_pk_add_f32 v[18:19], v[18:19], 1.0 op_sel_hi:[1,0]
v_pk_add_f32 v[20:21], v[20:21], 1.0 op_sel_hi:[1,0]
v_pk_add_f32 v[22:23], v[22:23], 1.0 op_sel_hi:[1,0]
v_rcp_f32 v16, v16
v_rcp_f32 v17, v17
v_rcp_f32 v18, v18
v_rcp_f32 v19, v19
v_rcp_f32 v20, v20
v_rcp_f32 v21, v21
v_rcp_f32 v22, v22
v_rcp_f32 v23, v23
v_pk_mul_f32 v[164:165], v[176:177], v[16:17]
v_pk_mul_f32 v[166:167], v[178:179], v[18:19]
v_pk_mul_f32 v[188:189], v[200:201], v[20:21]
v_pk_mul_f32 v[190:191], v[202:203], v[22:23]
v_cvt_pk_bf16_f32 v64, v164, v165
v_cvt_pk_bf16_f32 v65, v166, v167
v_cvt_pk_bf16_f32 v66, v188, v189
v_cvt_pk_bf16_f32 v67, v190, v191
v_pk_mul_f32 v[224:225], v[212:213], v[224:225]
v_pk_mul_f32 v[226:227], v[214:215], v[226:227]
v_pk_mul_f32 v[248:249], v[236:237], v[248:249]
v_pk_mul_f32 v[250:251], v[238:239], v[250:251]
v_permlane16_swap_b32 v64, v66
v_permlane16_swap_b32 v65, v67
buffer_store_dwordx4 v[64:67], v14, s[68:71], s5 offen offset:1024 sc1
v_pk_mul_f32 v[24:25], v[212:213], s[44:45]
v_pk_mul_f32 v[26:27], v[214:215], s[44:45]
v_pk_mul_f32 v[28:29], v[236:237], s[44:45]
v_pk_mul_f32 v[30:31], v[238:239], s[44:45]
v_exp_f32 v24, v24
v_exp_f32 v25, v25
v_exp_f32 v26, v26
v_exp_f32 v27, v27
v_exp_f32 v28, v28
v_exp_f32 v29, v29
v_exp_f32 v30, v30
v_exp_f32 v31, v31
v_pk_add_f32 v[24:25], v[24:25], 1.0 op_sel_hi:[1,0]
v_pk_add_f32 v[26:27], v[26:27], 1.0 op_sel_hi:[1,0]
v_pk_add_f32 v[28:29], v[28:29], 1.0 op_sel_hi:[1,0]
v_pk_add_f32 v[30:31], v[30:31], 1.0 op_sel_hi:[1,0]
v_rcp_f32 v24, v24
v_rcp_f32 v25, v25
v_rcp_f32 v26, v26
v_rcp_f32 v27, v27
v_rcp_f32 v28, v28
v_rcp_f32 v29, v29
v_rcp_f32 v30, v30
v_rcp_f32 v31, v31
v_pk_mul_f32 v[212:213], v[224:225], v[24:25]
v_pk_mul_f32 v[214:215], v[226:227], v[26:27]
v_pk_mul_f32 v[236:237], v[248:249], v[28:29]
v_pk_mul_f32 v[238:239], v[250:251], v[30:31]
v_cvt_pk_bf16_f32 v68, v212, v213
v_cvt_pk_bf16_f32 v69, v214, v215
v_cvt_pk_bf16_f32 v70, v236, v237
v_cvt_pk_bf16_f32 v71, v238, v239
v_pk_mul_f32 v[132:133], v[120:121], v[132:133]
v_pk_mul_f32 v[134:135], v[122:123], v[134:135]
v_pk_mul_f32 v[156:157], v[144:145], v[156:157]
v_pk_mul_f32 v[158:159], v[146:147], v[158:159]
v_permlane16_swap_b32 v68, v70
v_permlane16_swap_b32 v69, v71
buffer_store_dwordx4 v[68:71], v14, s[68:71], s6 offen offset:1024 sc1
v_pk_mul_f32 v[16:17], v[120:121], s[44:45]
v_pk_mul_f32 v[18:19], v[122:123], s[44:45]
v_pk_mul_f32 v[20:21], v[144:145], s[44:45]
v_pk_mul_f32 v[22:23], v[146:147], s[44:45]
v_exp_f32 v16, v16
v_exp_f32 v17, v17
v_exp_f32 v18, v18
v_exp_f32 v19, v19
v_exp_f32 v20, v20
v_exp_f32 v21, v21
v_exp_f32 v22, v22
v_exp_f32 v23, v23
v_pk_add_f32 v[16:17], v[16:17], 1.0 op_sel_hi:[1,0]
v_pk_add_f32 v[18:19], v[18:19], 1.0 op_sel_hi:[1,0]
v_pk_add_f32 v[20:21], v[20:21], 1.0 op_sel_hi:[1,0]
v_pk_add_f32 v[22:23], v[22:23], 1.0 op_sel_hi:[1,0]
v_rcp_f32 v16, v16
v_rcp_f32 v17, v17
v_rcp_f32 v18, v18
v_rcp_f32 v19, v19
v_rcp_f32 v20, v20
v_rcp_f32 v21, v21
v_rcp_f32 v22, v22
v_rcp_f32 v23, v23
v_pk_mul_f32 v[120:121], v[132:133], v[16:17]
v_pk_mul_f32 v[122:123], v[134:135], v[18:19]
v_pk_mul_f32 v[144:145], v[156:157], v[20:21]
v_pk_mul_f32 v[146:147], v[158:159], v[22:23]
v_cvt_pk_bf16_f32 v72, v120, v121
v_cvt_pk_bf16_f32 v73, v122, v123
v_cvt_pk_bf16_f32 v74, v144, v145
v_cvt_pk_bf16_f32 v75, v146, v147
v_pk_mul_f32 v[180:181], v[168:169], v[180:181]
v_pk_mul_f32 v[182:183], v[170:171], v[182:183]
v_pk_mul_f32 v[204:205], v[192:193], v[204:205]
v_pk_mul_f32 v[206:207], v[194:195], v[206:207]
v_permlane16_swap_b32 v72, v74
v_permlane16_swap_b32 v73, v75
buffer_store_dwordx4 v[72:75], v14, s[68:71], s7 offen offset:2048 sc1
v_pk_mul_f32 v[24:25], v[168:169], s[44:45]
v_pk_mul_f32 v[26:27], v[170:171], s[44:45]
v_pk_mul_f32 v[28:29], v[192:193], s[44:45]
v_pk_mul_f32 v[30:31], v[194:195], s[44:45]
v_exp_f32 v24, v24
v_exp_f32 v25, v25
v_exp_f32 v26, v26
v_exp_f32 v27, v27
v_exp_f32 v28, v28
v_exp_f32 v29, v29
v_exp_f32 v30, v30
v_exp_f32 v31, v31
v_pk_add_f32 v[24:25], v[24:25], 1.0 op_sel_hi:[1,0]
v_pk_add_f32 v[26:27], v[26:27], 1.0 op_sel_hi:[1,0]
v_pk_add_f32 v[28:29], v[28:29], 1.0 op_sel_hi:[1,0]
v_pk_add_f32 v[30:31], v[30:31], 1.0 op_sel_hi:[1,0]
v_rcp_f32 v24, v24
v_rcp_f32 v25, v25
v_rcp_f32 v26, v26
v_rcp_f32 v27, v27
v_rcp_f32 v28, v28
v_rcp_f32 v29, v29
v_rcp_f32 v30, v30
v_rcp_f32 v31, v31
v_pk_mul_f32 v[168:169], v[180:181], v[24:25]
v_pk_mul_f32 v[170:171], v[182:183], v[26:27]
v_pk_mul_f32 v[192:193], v[204:205], v[28:29]
v_pk_mul_f32 v[194:195], v[206:207], v[30:31]
v_cvt_pk_bf16_f32 v76, v168, v169
v_cvt_pk_bf16_f32 v77, v170, v171
v_cvt_pk_bf16_f32 v78, v192, v193
v_cvt_pk_bf16_f32 v79, v194, v195
v_pk_mul_f32 v[228:229], v[216:217], v[228:229]
v_pk_mul_f32 v[230:231], v[218:219], v[230:231]
v_pk_mul_f32 v[252:253], v[240:241], v[252:253]
v_pk_mul_f32 v[254:255], v[242:243], v[254:255]
v_permlane16_swap_b32 v76, v78
v_permlane16_swap_b32 v77, v79
buffer_store_dwordx4 v[76:79], v14, s[68:71], s8 offen offset:2048 sc1
v_pk_mul_f32 v[16:17], v[216:217], s[44:45]
v_pk_mul_f32 v[18:19], v[218:219], s[44:45]
v_pk_mul_f32 v[20:21], v[240:241], s[44:45]
v_pk_mul_f32 v[22:23], v[242:243], s[44:45]
v_exp_f32 v16, v16
v_exp_f32 v17, v17
v_exp_f32 v18, v18
v_exp_f32 v19, v19
v_exp_f32 v20, v20
v_exp_f32 v21, v21
v_exp_f32 v22, v22
v_exp_f32 v23, v23
v_pk_add_f32 v[16:17], v[16:17], 1.0 op_sel_hi:[1,0]
v_pk_add_f32 v[18:19], v[18:19], 1.0 op_sel_hi:[1,0]
v_pk_add_f32 v[20:21], v[20:21], 1.0 op_sel_hi:[1,0]
v_pk_add_f32 v[22:23], v[22:23], 1.0 op_sel_hi:[1,0]
v_rcp_f32 v16, v16
v_rcp_f32 v17, v17
v_rcp_f32 v18, v18
v_rcp_f32 v19, v19
v_rcp_f32 v20, v20
v_rcp_f32 v21, v21
v_rcp_f32 v22, v22
v_rcp_f32 v23, v23
v_pk_mul_f32 v[216:217], v[228:229], v[16:17]
v_pk_mul_f32 v[218:219], v[230:231], v[18:19]
v_pk_mul_f32 v[240:241], v[252:253], v[20:21]
v_pk_mul_f32 v[242:243], v[254:255], v[22:23]
v_cvt_pk_bf16_f32 v64, v216, v217
v_cvt_pk_bf16_f32 v65, v218, v219
v_cvt_pk_bf16_f32 v66, v240, v241
v_cvt_pk_bf16_f32 v67, v242, v243
s_nop 0
v_permlane16_swap_b32 v64, v66
v_permlane16_swap_b32_e64 v65, v67
buffer_store_dwordx4 v[64:67], v14, s[68:71], s9 offen offset:2048 sc1
L_signal:
s_and_b32 s38, s2, 6
s_lshr_b32 s39, s2, 5
s_lshl2_add_u32 s34, s38, s39
s_and_b32 s38, s2, 1
s_bfe_u32 s35, s2, 0x20003
s_lshl2_add_u32 s35, s38, s35
s_mov_b32 s80, s20
s_mov_b32 s81, s21
s_mov_b32 s82, 2097152
s_mov_b32 s83, 0x20000
s_lshl3_add_u32 s38, s34, s35
s_lshl_b32 s38, s38, 8
s_add_u32 s38, s38, 9527296
s_add_u32 s10, s24, s38
s_addc_u32 s11, s25, 0
s_lshl3_add_u32 s38, s34, s35
s_lshl_b32 s38, s38, 7
s_add_u32 s38, s38, 9494528
s_add_u32 s18, s24, s38
s_addc_u32 s19, s25, 0
v_mov_b32 v17, 1
v_lshrrev_b32 v20, 3, v2
v_and_b32 v21, 7, v2
v_lshrrev_b32 v18, 1, v20
v_and_b32 v19, 1, v20
v_lshl_or_b32 v18, v19, 2, v18
v_and_b32 v19, 3, v21
v_lshlrev_b32 v19, 1, v19
v_xor_b32 v18, v18, v19
v_lshlrev_b32 v18, 4, v18
v_lshl_add_u32 v18, v20, 7, v18
s_lshl_b32 s38, s26, 10
v_add_u32 v18, s38, v18
v_lshrrev_b32 v19, 2, v21
v_mul_u32_u24 v26, 40960, v19
v_add_u32 v26, v26, v18
v_add_u32 v26, 57344, v26
v_xor_b32 v27, 16, v26
v_mul_u32_u24 v28, 4096, v19
v_add_u32 v28, v28, v18
v_add_u32 v28, 102400, v28
v_xor_b32 v29, 16, v28
v_lshlrev_b32 v19, 2, v20
s_lshl_b32 s44, s34, 8
s_lshl_b32 s38, s26, 5
s_add_u32 s44, s44, s38
s_add_u32 s44, s44, 7864320
v_lshlrev_b32 v16, 10, v20
v_lshl_add_u32 v16, v21, 4, v16
s_lshl_b32 s40, s34, 16
s_lshl_b32 s39, s26, 13
s_add_u32 s40, s40, s39
s_lshl_b32 s39, s35, 7
s_add_u32 s40, s40, s39
s_xor_b32 s41, s40, 32768
s_xor_b32 s45, s44, 128
s_mov_b32 s42, 0x42200000
s_cmp_eq_u32 s26, 3
s_mov_b32 exec_lo, s15
s_mov_b32 exec_hi, 0
s_waitcnt vmcnt(0)
s_barrier
s_cbranch_scc0 L_nosig
buffer_store_dword v17, v0, s[64:67], s51 offen sc1
L_nosig:
s_mov_b64 exec, -1
L_hwait:
s_cmp_eq_u32 s26, 0
s_cbranch_scc0 L_hw_done
s_mov_b32 s47, 131072
L_hw_loop:
s_load_dwordx8 s[84:91], s[10:11], 0 glc
s_load_dwordx8 s[92:99], s[10:11], 128 glc
L_hw_chk:
s_waitcnt lgkmcnt(0)
s_and_b64 s[84:85], s[84:85], s[86:87]
s_and_b64 s[88:89], s[88:89], s[90:91]
s_and_b64 s[92:93], s[92:93], s[94:95]
s_and_b64 s[96:97], s[96:97], s[84:85]
s_and_b64 s[88:89], s[88:89], s[92:93]
s_and_b64 s[96:97], s[96:97], s[88:89]
s_and_b32 s96, s96, s98
s_and_b32 s96, s96, s97
s_cbranch_scc1 L_hw_done
s_sub_u32 s47, s47, 1
s_cmp_lg_u32 s47, 0
s_cbranch_scc1 L_hw_loop
L_hw_done:
s_barrier
L_owait:
s_cmp_eq_u32 s26, 0
s_cbranch_scc0 L_ow_done
s_mov_b32 s47, 131072
L_ow_loop:
s_load_dwordx8 s[84:91], s[18:19], 0 glc
L_ow_chk:
s_waitcnt lgkmcnt(0)
s_and_b64 s[84:85], s[84:85], s[86:87]
s_and_b64 s[88:89], s[88:89], s[90:91]
s_and_b64 s[84:85], s[84:85], s[88:89]
s_and_b32 s84, s84, s85
s_cbranch_scc1 L_ow_done
s_sub_u32 s47, s47, 1
s_cmp_lg_u32 s47, 0
s_cbranch_scc1 L_ow_loop
L_ow_done:
s_barrier
buffer_load_dword v30, v19, s[64:67], s44 offen sc1
buffer_load_dword v32, v19, s[64:67], s45 offen sc1
s_waitcnt vmcnt(0)
v_med3_f32 v30, v30, s42, -s42
v_mul_f32 v30, 0xbfb8aa3b, v30
v_exp_f32 v30, v30
s_nop 0
v_add_f32 v30, 1.0, v30
v_rcp_f32 v30, v30
v_med3_f32 v32, v32, s42, -s42
v_mul_f32 v32, 0xbfb8aa3b, v32
v_exp_f32 v32, v32
s_nop 0
v_add_f32 v32, 1.0, v32
v_rcp_f32 v32, v32
s_barrier
ds_read_b128 v[128:131], v26 offset:0
ds_read_b128 v[132:135], v27 offset:0
ds_read_b128 v[136:139], v26 offset:12288
ds_read_b128 v[140:143], v27 offset:12288
ds_read_b128 v[144:147], v26 offset:24576
ds_read_b128 v[148:151], v27 offset:24576
ds_read_b128 v[152:155], v26 offset:36864
ds_read_b128 v[156:159], v27 offset:36864
s_waitcnt lgkmcnt(4)
v_add_f32 v128, v128, v136
v_add_f32 v129, v129, v137
v_add_f32 v130, v130, v138
v_add_f32 v131, v131, v139
v_add_f32 v132, v132, v140
v_add_f32 v133, v133, v141
v_add_f32 v134, v134, v142
v_add_f32 v135, v135, v143
s_waitcnt lgkmcnt(0)
v_add_f32 v144, v144, v152
v_add_f32 v145, v145, v153
v_add_f32 v146, v146, v154
v_add_f32 v147, v147, v155
v_add_f32 v148, v148, v156
v_add_f32 v149, v149, v157
v_add_f32 v150, v150, v158
v_add_f32 v151, v151, v159
v_add_f32 v128, v128, v144
v_add_f32 v129, v129, v145
v_add_f32 v130, v130, v146
v_add_f32 v131, v131, v147
v_add_f32 v132, v132, v148
v_add_f32 v133, v133, v149
v_add_f32 v134, v134, v150
v_add_f32 v135, v135, v151
v_mul_f32 v128, v128, v30
v_mul_f32 v129, v129, v30
v_mul_f32 v130, v130, v30
v_mul_f32 v131, v131, v30
v_mul_f32 v132, v132, v30
v_mul_f32 v133, v133, v30
v_mul_f32 v134, v134, v30
v_mul_f32 v135, v135, v30
v_cvt_pk_bf16_f32 v72, v128, v129
v_cvt_pk_bf16_f32 v73, v130, v131
v_cvt_pk_bf16_f32 v74, v132, v133
v_cvt_pk_bf16_f32 v75, v134, v135
buffer_store_dwordx4 v[72:75], v16, s[80:83], s40 offen sc1
s_barrier
s_nop 0
ds_read_b128 v[128:131], v28 offset:0
ds_read_b128 v[132:135], v29 offset:0
ds_read_b128 v[136:139], v28 offset:12288
ds_read_b128 v[140:143], v29 offset:12288
ds_read_b128 v[144:147], v28 offset:24576
ds_read_b128 v[148:151], v29 offset:24576
ds_read_b128 v[152:155], v28 offset:36864
ds_read_b128 v[156:159], v29 offset:36864
s_waitcnt lgkmcnt(4)
s_nop 0
v_pk_add_f32 v[128:129], v[128:129], v[136:137]
v_pk_add_f32 v[130:131], v[130:131], v[138:139]
v_pk_add_f32 v[132:133], v[132:133], v[140:141]
v_pk_add_f32 v[134:135], v[134:135], v[142:143]
s_waitcnt lgkmcnt(0)
s_nop 0
v_pk_add_f32 v[144:145], v[144:145], v[152:153]
v_pk_add_f32 v[146:147], v[146:147], v[154:155]
v_pk_add_f32 v[148:149], v[148:149], v[156:157]
v_pk_add_f32 v[150:151], v[150:151], v[158:159]
v_pk_add_f32 v[128:129], v[128:129], v[144:145]
v_pk_add_f32 v[130:131], v[130:131], v[146:147]
v_pk_add_f32 v[132:133], v[132:133], v[148:149]
v_pk_add_f32 v[134:135], v[134:135], v[150:151]
v_pk_mul_f32 v[128:129], v[128:129], v[32:33] op_sel_hi:[1,0]
v_pk_mul_f32 v[130:131], v[130:131], v[32:33] op_sel_hi:[1,0]
v_pk_mul_f32 v[132:133], v[132:133], v[32:33] op_sel_hi:[1,0]
v_pk_mul_f32 v[134:135], v[134:135], v[32:33] op_sel_hi:[1,0]
v_cvt_pk_bf16_f32 v76, v128, v129
v_cvt_pk_bf16_f32 v77, v130, v131
v_cvt_pk_bf16_f32 v78, v132, v133
v_cvt_pk_bf16_f32 v79, v134, v135
buffer_store_dwordx4 v[76:79], v16, s[80:83], s41 offen sc1
L_fin:
s_endpgm
L_gate:
v_lshlrev_b32 v13, 4, v9
v_add_u32 v13, 147456, v13
v_mov_b32 v12, v13
s_add_u32 s40, s27, s28
s_bitcmp1_b32 s40, 0
s_mov_b32 s32, 0x76543210
s_cselect_b32 s32, 0x75634120, s32
s_mul_i32 s38, s27, 6
s_mul_i32 s39, s48, 3
s_add_u32 s50, s38, s39
v_lshlrev_b32 v14, 4, v2
v_lshlrev_b32 v15, 2, v2
s_mov_b32 s64, s24
s_mov_b32 s65, s25
s_mov_b32 s66, 268435456
s_mov_b32 s67, 0x20000
s_mov_b32 s68, s24
s_mov_b32 s69, s25
s_mov_b32 s70, 7733248
s_mov_b32 s71, 0x20000
s_cmp_eq_u32 s27, 10
s_mov_b32 s15, 0xffffff
s_cselect_b32 s15, 0xffff, s15
s_mul_i32 s51, s27, 48
s_lshr_b32 s38, s31, 3
s_add_u32 s51, s51, s38
s_lshl_b32 s51, s51, 5
s_and_b32 s38, s31, 7
s_add_u32 s51, s51, s38
s_lshl2_add_u32 s51, s51, 9527296
v_lshlrev_b32_e64 v0, 8, v2
s_barrier
ds_read_b128 v[40:43], v12 offset:0
ds_read_b128 v[16:19], v10 offset:0
ds_read_b128 v[20:23], v10 offset:2048
ds_read_b128 v[24:27], v10 offset:4096
ds_read_b128 v[28:31], v10 offset:6144
ds_read_b128 v[32:35], v10 offset:8192
ds_read_b128 v[36:39], v10 offset:10240
s_waitcnt lgkmcnt(0)
s_nop 0
L_loop_gate:
v_mfma_f32_16x16x32_bf16 v[112:115], v[40:43], v[16:19], v[112:115]
ds_read_b128 v[88:91], v12 offset:64
v_mfma_f32_16x16x32_bf16 v[136:139], v[40:43], v[20:23], v[136:139]
ds_read_b128 v[64:67], v11 offset:0
v_mfma_f32_16x16x32_bf16 v[160:163], v[40:43], v[24:27], v[160:163]
ds_read_b128 v[68:71], v11 offset:2048
v_mfma_f32_16x16x32_bf16 v[184:187], v[40:43], v[28:31], v[184:187]
ds_read_b128 v[72:75], v11 offset:4096
v_mfma_f32_16x16x32_bf16 v[208:211], v[40:43], v[32:35], v[208:211]
ds_read_b128 v[76:79], v11 offset:6144
v_mfma_f32_16x16x32_bf16 v[232:235], v[40:43], v[36:39], v[232:235]
ds_read_b128 v[80:83], v11 offset:8192
ds_read_b128 v[84:87], v11 offset:10240
s_add_u32 s52, s52, 1
s_cmp_eq_u32 s52, 3
s_mov_b32 s54, 49152
s_cselect_b32 s54, -98304, s54
v_add_u32 v10, s54, v10
v_add_u32 v11, s54, v11
s_cselect_b32 s52, 0, s52
s_lshr_b32 s32, s32, 4
s_and_b32 s46, s32, 7
s_lshl_b32 s46, s46, 7
v_add_u32_e64 v12, s46, v13
s_waitcnt lgkmcnt(0)
s_nop 0
v_mfma_f32_16x16x32_bf16 v[112:115], v[88:91], v[64:67], v[112:115]
s_barrier
s_sub_u32 s53, s53, 1
v_mfma_f32_16x16x32_bf16 v[136:139], v[88:91], v[68:71], v[136:139]
ds_read_b128 v[40:43], v12 offset:0
v_mfma_f32_16x16x32_bf16 v[160:163], v[88:91], v[72:75], v[160:163]
ds_read_b128 v[16:19], v10 offset:0
v_mfma_f32_16x16x32_bf16 v[184:187], v[88:91], v[76:79], v[184:187]
ds_read_b128 v[20:23], v10 offset:2048
v_mfma_f32_16x16x32_bf16 v[208:211], v[88:91], v[80:83], v[208:211]
ds_read_b128 v[24:27], v10 offset:4096
v_mfma_f32_16x16x32_bf16 v[232:235], v[88:91], v[84:87], v[232:235]
ds_read_b128 v[28:31], v10 offset:6144
ds_read_b128 v[32:35], v10 offset:8192
ds_read_b128 v[36:39], v10 offset:10240
s_waitcnt lgkmcnt(0)
s_cbranch_scc0 L_loop_gate
ds_read_b128 v[88:91], v12 offset:64
ds_read_b128 v[64:67], v11 offset:0
ds_read_b128 v[68:71], v11 offset:2048
ds_read_b128 v[72:75], v11 offset:4096
ds_read_b128 v[76:79], v11 offset:6144
ds_read_b128 v[80:83], v11 offset:8192
ds_read_b128 v[84:87], v11 offset:10240
v_mfma_f32_16x16x32_bf16 v[112:115], v[40:43], v[16:19], v[112:115]
v_mfma_f32_16x16x32_bf16 v[136:139], v[40:43], v[20:23], v[136:139]
v_mfma_f32_16x16x32_bf16 v[160:163], v[40:43], v[24:27], v[160:163]
v_mfma_f32_16x16x32_bf16 v[184:187], v[40:43], v[28:31], v[184:187]
v_mfma_f32_16x16x32_bf16 v[208:211], v[40:43], v[32:35], v[208:211]
v_mfma_f32_16x16x32_bf16 v[232:235], v[40:43], v[36:39], v[232:235]
s_waitcnt lgkmcnt(0)
s_nop 0
v_mfma_f32_16x16x32_bf16 v[112:115], v[88:91], v[64:67], v[112:115]
v_mfma_f32_16x16x32_bf16 v[136:139], v[88:91], v[68:71], v[136:139]
v_mfma_f32_16x16x32_bf16 v[160:163], v[88:91], v[72:75], v[160:163]
v_mfma_f32_16x16x32_bf16 v[184:187], v[88:91], v[76:79], v[184:187]
v_mfma_f32_16x16x32_bf16 v[208:211], v[88:91], v[80:83], v[208:211]
v_mfma_f32_16x16x32_bf16 v[232:235], v[88:91], v[84:87], v[232:235]
s_add_u32 s40, s24, 7864320
s_addc_u32 s41, s25, 0
s_mov_b32 s42, 8192
s_mov_b32 s43, 0x20000
s_lshl_b32 s39, s50, 7
s_mov_b32 exec_lo, 0xffff
s_mov_b32 exec_hi, 0
buffer_store_dword v112, v15, s[40:43], s39 offen offset:0 sc1
buffer_store_dword v136, v15, s[40:43], s39 offen offset:64 sc1
buffer_store_dword v160, v15, s[40:43], s39 offen offset:128 sc1
buffer_store_dword v184, v15, s[40:43], s39 offen offset:192 sc1
buffer_store_dword v208, v15, s[40:43], s39 offen offset:256 sc1
buffer_store_dword v232, v15, s[40:43], s39 offen offset:320 sc1
s_mov_b64 exec, -1
s_branch L_signal
L_c_idle:
v_lshlrev_b32 v21, 4, v0
s_mov_b32 s64, s24
s_mov_b32 s65, s25
s_mov_b32 s66, 268435456
s_mov_b32 s67, 0x20000
s_barrier
s_add_u32 s40, s24, 9437184
s_addc_u32 s41, s25, 0
s_mov_b32 s42, 155648
s_mov_b32 s43, 0x20000
s_sub_u32 s38, s2, 247
s_lshl_b32 s38, s38, 10
L_clr_loop:
buffer_store_dwordx4 v[112:115], v21, s[40:43], s38 offen sc1
s_add_u32 s38, s38, 12288
s_cmp_lt_u32 s38, s42
s_cbranch_scc1 L_clr_loop
s_mov_b32 s88, s22
s_mov_b32 s89, s23
s_mov_b32 s90, 256
s_mov_b32 s91, 0x20000
v_mov_b32 v17, 1
s_waitcnt vmcnt(0)
s_mov_b32 exec_lo, 1
s_mov_b32 exec_hi, 0
ds_add_rtn_u32 v25, v6, v17 offset:0
s_waitcnt lgkmcnt(0)
v_readfirstlane_b32 s38, v25
s_nop 0
s_cmp_eq_u32 s38, 3
s_cbranch_scc0 L_c_idle1
buffer_atomic_add v17, off, s[88:91], 0
L_c_idle1:
s_mov_b64 exec, -1
s_waitcnt vmcnt(0)
s_barrier
s_and_b32 s38, s2, 6
s_lshr_b32 s39, s2, 5
s_lshl2_add_u32 s34, s38, s39
s_and_b32 s38, s2, 1
s_bfe_u32 s35, s2, 0x20003
s_lshl2_add_u32 s35, s38, s35
s_mov_b32 s80, s20
s_mov_b32 s81, s21
s_mov_b32 s82, 2097152
s_mov_b32 s83, 0x20000
s_lshl3_add_u32 s38, s34, s35
s_lshl_b32 s38, s38, 8
s_add_u32 s38, s38, 9527296
s_add_u32 s10, s24, s38
s_addc_u32 s11, s25, 0
s_lshl3_add_u32 s38, s34, s35
s_lshl_b32 s38, s38, 7
s_add_u32 s38, s38, 9494528
s_add_u32 s18, s24, s38
s_addc_u32 s19, s25, 0
v_mov_b32 v17, 1
v_lshrrev_b32 v20, 3, v2
v_and_b32 v21, 7, v2
v_lshrrev_b32 v18, 1, v20
v_and_b32 v19, 1, v20
v_lshl_or_b32 v18, v19, 2, v18
v_and_b32 v19, 3, v21
v_lshlrev_b32 v19, 1, v19
v_xor_b32 v18, v18, v19
v_lshlrev_b32 v18, 4, v18
v_lshl_add_u32 v18, v20, 7, v18
s_lshl_b32 s38, s26, 10
v_add_u32 v18, s38, v18
v_lshrrev_b32 v19, 2, v21
v_mul_u32_u24 v26, 40960, v19
v_add_u32 v26, v26, v18
v_add_u32 v26, 57344, v26
v_xor_b32 v27, 16, v26
v_mul_u32_u24 v28, 4096, v19
v_add_u32 v28, v28, v18
v_add_u32 v28, 102400, v28
v_xor_b32 v29, 16, v28
v_lshlrev_b32 v19, 2, v20
s_lshl_b32 s44, s34, 8
s_lshl_b32 s38, s26, 5
s_add_u32 s44, s44, s38
s_add_u32 s44, s44, 7864320
v_lshlrev_b32 v16, 10, v20
v_lshl_add_u32 v16, v21, 4, v16
s_lshl_b32 s40, s34, 16
s_lshl_b32 s39, s26, 13
s_add_u32 s40, s40, s39
s_lshl_b32 s39, s35, 7
s_add_u32 s40, s40, s39
s_xor_b32 s41, s40, 32768
s_xor_b32 s45, s44, 128
s_mov_b32 s42, 0x42200000
s_barrier
s_branch L_hwait
L_pad2:
s_branch L_cons
L_qkv:
v_mul_u32_u24 v12, 3072, v9
v_lshl_add_u32 v12, v17, 7, v12
v_and_b32 v17, 2, v17
v_or_b32 v17, v17, v20
s_lshl_b32 s38, s49, 1
v_xor_b32 v17, s38, v17
v_lshl_add_u32 v12, v17, 5, v12
v_lshl_add_u32 v12, v18, 3, v12
v_add_u32 v12, 24576, v12
v_xor_b32 v13, 32, v12
s_mov_b32 s44, 0x3fb8aa3b
s_mov_b32 s45, 0x3fb8aa3b
s_mov_b32 s42, 0x358637bd
s_mov_b32 s43, 0x358637bd
s_mul_i32 s38, s27, 6
s_mul_i32 s39, s48, 3
s_add_u32 s50, s38, s39
v_lshlrev_b32 v14, 4, v2
v_lshlrev_b32 v15, 2, v2
s_mov_b32 s64, s24
s_mov_b32 s65, s25
s_mov_b32 s66, 268435456
s_mov_b32 s67, 0x20000
s_mov_b32 s68, s24
s_mov_b32 s69, s25
s_mov_b32 s70, 7733248
s_mov_b32 s71, 0x20000
s_cmp_eq_u32 s27, 10
s_mov_b32 s15, 0xffffff
s_cselect_b32 s15, 0xffff, s15
v_lshlrev_b32 v0, 7, v2
s_mul_i32 s38, s29, 1408
s_add_u32 s38, s38, 9472000
s_lshl2_add_u32 s51, s27, s38
s_xor_b32 s38, s29, 1
s_mul_i32 s38, s38, 11
s_add_u32 s38, s38, s27
s_lshl_b32 s38, s38, 7
s_add_u32 s38, s38, 9472000
s_add_u32 s16, s24, s38
s_addc_u32 s17, s25, 0
s_mul_i32 s7, s27, 768
s_add_u32 s7, s7, s29
s_lshl2_add_u32 s7, s7, 9494528
s_lshl_b32 s38, s26, 11
s_add_u32 s38, s38, 148480
v_and_b32 v20, 1, v9
v_and_b32 v18, 3, v2
v_lshrrev_b32 v17, 1, v9
v_lshlrev_b32 v4, 10, v20
v_lshl_add_u32 v4, v17, 9, v4
v_xor_b32 v20, 1, v20
v_lshlrev_b32 v5, 5, v17
v_lshl_add_u32 v5, v20, 6, v5
v_bfe_u32 v17, v2, 2, 1
v_bfe_u32 v19, v2, 3, 1
v_lshl_or_b32 v18, v17, 3, v18
v_lshl_or_b32 v18, v19, 2, v18
v_lshl_add_u32 v4, v18, 4, v4
v_add_u32 v4, s38, v4
v_add_u32 v1, s38, v15
s_lshl1_add_u32 s38, s29, s49
s_lshl_b32 s8, s38, 11
s_add_u32 s8, s8, 9437184
s_lshl_b32 s9, s38, 7
s_add_u32 s9, s9, 9469952
s_mov_b32 s22, s8
s_mov_b32 s23, s9
s_xor_b32 s38, s38, 2
s_lshl1_add_u32 s38, s38, 86
s_mul_i32 s39, s50, 118
s_add_u32 s39, s39, s38
s_lshl_b32 s4, s39, 10
s_add_u32 s5, s4, 120832
s_add_u32 s6, s4, 241664
s_mov_b32 s12, 0xffff0000
s_mov_b32 s13, 0xffff0000
s_barrier
s_nop 0
ds_read_b64_tr_b16 v[40:41], v12 offset:0
ds_read_b64_tr_b16 v[42:43], v12 offset:512
ds_read_b128 v[16:19], v10 offset:0
ds_read_b128 v[20:23], v10 offset:2048
ds_read_b128 v[24:27], v10 offset:4096
ds_read_b128 v[28:31], v10 offset:6144
ds_read_b128 v[32:35], v10 offset:8192
ds_read_b128 v[36:39], v10 offset:10240
ds_read_b64_tr_b16 v[44:45], v13 offset:0
ds_read_b64_tr_b16 v[46:47], v13 offset:512
ds_read_b64_tr_b16 v[48:49], v12 offset:1024
ds_read_b64_tr_b16 v[50:51], v12 offset:1536
ds_read_b64_tr_b16 v[52:53], v13 offset:1024
ds_read_b64_tr_b16 v[54:55], v13 offset:1536
ds_read_b64_tr_b16 v[56:57], v12 offset:2048
ds_read_b64_tr_b16 v[58:59], v12 offset:2560
ds_read_b64_tr_b16 v[60:61], v13 offset:2048
ds_read_b64_tr_b16 v[62:63], v13 offset:2560
s_waitcnt lgkmcnt(0)
s_nop 0
L_loop_qkv:
v_mfma_f32_16x16x32_bf16 v[112:115], v[40:43], v[16:19], v[112:115]
ds_read_b64_tr_b16 v[88:89], v12 offset:12288
v_mfma_f32_16x16x32_bf16 v[136:139], v[40:43], v[20:23], v[136:139]
ds_read_b64_tr_b16 v[90:91], v12 offset:12800
v_mfma_f32_16x16x32_bf16 v[160:163], v[40:43], v[24:27], v[160:163]
ds_read_b128 v[64:67], v11 offset:0
v_mfma_f32_16x16x32_bf16 v[184:187], v[40:43], v[28:31], v[184:187]
ds_read_b128 v[68:71], v11 offset:2048
v_mfma_f32_16x16x32_bf16 v[208:211], v[40:43], v[32:35], v[208:211]
ds_read_b128 v[72:75], v11 offset:4096
v_mfma_f32_16x16x32_bf16 v[232:235], v[40:43], v[36:39], v[232:235]
ds_read_b128 v[76:79], v11 offset:6144
v_mfma_f32_16x16x32_bf16 v[236:239], v[44:47], v[36:39], v[236:239]
ds_read_b128 v[80:83], v11 offset:8192
v_mfma_f32_16x16x32_bf16 v[212:215], v[44:47], v[32:35], v[212:215]
ds_read_b128 v[84:87], v11 offset:10240
v_mfma_f32_16x16x32_bf16 v[188:191], v[44:47], v[28:31], v[188:191]
ds_read_b64_tr_b16 v[92:93], v13 offset:12288
v_mfma_f32_16x16x32_bf16 v[164:167], v[44:47], v[24:27], v[164:167]
ds_read_b64_tr_b16 v[94:95], v13 offset:12800
v_mfma_f32_16x16x32_bf16 v[140:143], v[44:47], v[20:23], v[140:143]
ds_read_b64_tr_b16 v[96:97], v12 offset:13312
v_mfma_f32_16x16x32_bf16 v[116:119], v[44:47], v[16:19], v[116:119]
ds_read_b64_tr_b16 v[98:99], v12 offset:13824
v_mfma_f32_16x16x32_bf16 v[120:123], v[16:19], v[48:51], v[120:123]
ds_read_b64_tr_b16 v[100:101], v13 offset:13312
v_mfma_f32_16x16x32_bf16 v[144:147], v[20:23], v[48:51], v[144:147]
ds_read_b64_tr_b16 v[102:103], v13 offset:13824
v_mfma_f32_16x16x32_bf16 v[168:171], v[24:27], v[48:51], v[168:171]
ds_read_b64_tr_b16 v[104:105], v12 offset:14336
v_mfma_f32_16x16x32_bf16 v[192:195], v[28:31], v[48:51], v[192:195]
ds_read_b64_tr_b16 v[106:107], v12 offset:14848
v_mfma_f32_16x16x32_bf16 v[216:219], v[32:35], v[48:51], v[216:219]
ds_read_b64_tr_b16 v[108:109], v13 offset:14336
v_mfma_f32_16x16x32_bf16 v[240:243], v[36:39], v[48:51], v[240:243]
ds_read_b64_tr_b16 v[110:111], v13 offset:14848
v_mfma_f32_16x16x32_bf16 v[244:247], v[36:39], v[52:55], v[244:247]
s_add_u32 s52, s52, 1
s_cmp_eq_u32 s52, 3
v_mfma_f32_16x16x32_bf16 v[220:223], v[32:35], v[52:55], v[220:223]
s_mov_b32 s54, 49152
v_mfma_f32_16x16x32_bf16 v[196:199], v[28:31], v[52:55], v[196:199]
s_cselect_b32 s54, -98304, s54
v_mfma_f32_16x16x32_bf16 v[172:175], v[24:27], v[52:55], v[172:175]
v_add_u32 v10, s54, v10
v_add_u32 v11, s54, v11
v_mfma_f32_16x16x32_bf16 v[148:151], v[20:23], v[52:55], v[148:151]
v_add_u32 v12, s54, v12
v_add_u32 v13, s54, v13
v_mfma_f32_16x16x32_bf16 v[124:127], v[16:19], v[52:55], v[124:127]
v_mfma_f32_16x16x32_bf16 v[128:131], v[16:19], v[56:59], v[128:131]
v_mfma_f32_16x16x32_bf16 v[152:155], v[20:23], v[56:59], v[152:155]
v_mfma_f32_16x16x32_bf16 v[176:179], v[24:27], v[56:59], v[176:179]
v_mfma_f32_16x16x32_bf16 v[200:203], v[28:31], v[56:59], v[200:203]
v_mfma_f32_16x16x32_bf16 v[224:227], v[32:35], v[56:59], v[224:227]
v_mfma_f32_16x16x32_bf16 v[248:251], v[36:39], v[56:59], v[248:251]
v_mfma_f32_16x16x32_bf16 v[252:255], v[36:39], v[60:63], v[252:255]
v_mfma_f32_16x16x32_bf16 v[228:231], v[32:35], v[60:63], v[228:231]
v_mfma_f32_16x16x32_bf16 v[204:207], v[28:31], v[60:63], v[204:207]
v_mfma_f32_16x16x32_bf16 v[180:183], v[24:27], v[60:63], v[180:183]
v_mfma_f32_16x16x32_bf16 v[156:159], v[20:23], v[60:63], v[156:159]
v_mfma_f32_16x16x32_bf16 v[132:135], v[16:19], v[60:63], v[132:135]
s_waitcnt lgkmcnt(0)
s_cselect_b32 s52, 0, s52
v_mfma_f32_16x16x32_bf16 v[112:115], v[88:91], v[64:67], v[112:115]
v_mfma_f32_16x16x32_bf16 v[136:139], v[88:91], v[68:71], v[136:139]
v_mfma_f32_16x16x32_bf16 v[160:163], v[88:91], v[72:75], v[160:163]
v_mfma_f32_16x16x32_bf16 v[184:187], v[88:91], v[76:79], v[184:187]
v_mfma_f32_16x16x32_bf16 v[208:211], v[88:91], v[80:83], v[208:211]
v_mfma_f32_16x16x32_bf16 v[232:235], v[88:91], v[84:87], v[232:235]
v_mfma_f32_16x16x32_bf16 v[236:239], v[92:95], v[84:87], v[236:239]
v_mfma_f32_16x16x32_bf16 v[212:215], v[92:95], v[80:83], v[212:215]
v_mfma_f32_16x16x32_bf16 v[188:191], v[92:95], v[76:79], v[188:191]
v_mfma_f32_16x16x32_bf16 v[164:167], v[92:95], v[72:75], v[164:167]
v_mfma_f32_16x16x32_bf16 v[140:143], v[92:95], v[68:71], v[140:143]
s_barrier
s_sub_u32 s53, s53, 1
v_mfma_f32_16x16x32_bf16 v[116:119], v[92:95], v[64:67], v[116:119]
ds_read_b64_tr_b16 v[40:41], v12 offset:0
v_mfma_f32_16x16x32_bf16 v[120:123], v[64:67], v[96:99], v[120:123]
ds_read_b64_tr_b16 v[42:43], v12 offset:512
v_mfma_f32_16x16x32_bf16 v[144:147], v[68:71], v[96:99], v[144:147]
ds_read_b128 v[16:19], v10 offset:0
v_mfma_f32_16x16x32_bf16 v[168:171], v[72:75], v[96:99], v[168:171]
ds_read_b128 v[20:23], v10 offset:2048
v_mfma_f32_16x16x32_bf16 v[192:195], v[76:79], v[96:99], v[192:195]
ds_read_b128 v[24:27], v10 offset:4096
v_mfma_f32_16x16x32_bf16 v[216:219], v[80:83], v[96:99], v[216:219]
ds_read_b128 v[28:31], v10 offset:6144
v_mfma_f32_16x16x32_bf16 v[240:243], v[84:87], v[96:99], v[240:243]
ds_read_b128 v[32:35], v10 offset:8192
v_mfma_f32_16x16x32_bf16 v[244:247], v[84:87], v[100:103], v[244:247]
ds_read_b128 v[36:39], v10 offset:10240
v_mfma_f32_16x16x32_bf16 v[220:223], v[80:83], v[100:103], v[220:223]
ds_read_b64_tr_b16 v[44:45], v13 offset:0
v_mfma_f32_16x16x32_bf16 v[196:199], v[76:79], v[100:103], v[196:199]
ds_read_b64_tr_b16 v[46:47], v13 offset:512
v_mfma_f32_16x16x32_bf16 v[172:175], v[72:75], v[100:103], v[172:175]
ds_read_b64_tr_b16 v[48:49], v12 offset:1024
v_mfma_f32_16x16x32_bf16 v[148:151], v[68:71], v[100:103], v[148:151]
ds_read_b64_tr_b16 v[50:51], v12 offset:1536
v_mfma_f32_16x16x32_bf16 v[124:127], v[64:67], v[100:103], v[124:127]
ds_read_b64_tr_b16 v[52:53], v13 offset:1024
v_mfma_f32_16x16x32_bf16 v[128:131], v[64:67], v[104:107], v[128:131]
ds_read_b64_tr_b16 v[54:55], v13 offset:1536
v_mfma_f32_16x16x32_bf16 v[152:155], v[68:71], v[104:107], v[152:155]
ds_read_b64_tr_b16 v[56:57], v12 offset:2048
v_mfma_f32_16x16x32_bf16 v[176:179], v[72:75], v[104:107], v[176:179]
ds_read_b64_tr_b16 v[58:59], v12 offset:2560
v_mfma_f32_16x16x32_bf16 v[200:203], v[76:79], v[104:107], v[200:203]
ds_read_b64_tr_b16 v[60:61], v13 offset:2048
v_mfma_f32_16x16x32_bf16 v[224:227], v[80:83], v[104:107], v[224:227]
ds_read_b64_tr_b16 v[62:63], v13 offset:2560
v_mfma_f32_16x16x32_bf16 v[248:251], v[84:87], v[104:107], v[248:251]
v_mfma_f32_16x16x32_bf16 v[252:255], v[84:87], v[108:111], v[252:255]
v_mfma_f32_16x16x32_bf16 v[228:231], v[80:83], v[108:111], v[228:231]
v_mfma_f32_16x16x32_bf16 v[204:207], v[76:79], v[108:111], v[204:207]
v_mfma_f32_16x16x32_bf16 v[180:183], v[72:75], v[108:111], v[180:183]
v_mfma_f32_16x16x32_bf16 v[156:159], v[68:71], v[108:111], v[156:159]
v_mfma_f32_16x16x32_bf16 v[132:135], v[64:67], v[108:111], v[132:135]
s_waitcnt lgkmcnt(0)
s_cbranch_scc0 L_loop_qkv
v_mfma_f32_16x16x32_bf16 v[120:123], v[16:19], v[48:51], v[120:123]
ds_read_b128 v[64:67], v11 offset:0
ds_read_b128 v[68:71], v11 offset:2048
v_mfma_f32_16x16x32_bf16 v[144:147], v[20:23], v[48:51], v[144:147]
ds_read_b64_tr_b16 v[96:97], v12 offset:13312
ds_read_b64_tr_b16 v[98:99], v12 offset:13824
v_mfma_f32_16x16x32_bf16 v[168:171], v[24:27], v[48:51], v[168:171]
ds_read_b64_tr_b16 v[100:101], v13 offset:13312
ds_read_b64_tr_b16 v[102:103], v13 offset:13824
v_mfma_f32_16x16x32_bf16 v[192:195], v[28:31], v[48:51], v[192:195]
ds_read_b128 v[72:75], v11 offset:4096
ds_read_b128 v[76:79], v11 offset:6144
v_mfma_f32_16x16x32_bf16 v[216:219], v[32:35], v[48:51], v[216:219]
ds_read_b128 v[80:83], v11 offset:8192
ds_read_b128 v[84:87], v11 offset:10240
v_mfma_f32_16x16x32_bf16 v[240:243], v[36:39], v[48:51], v[240:243]
ds_read_b64_tr_b16 v[104:105], v12 offset:14336
ds_read_b64_tr_b16 v[106:107], v12 offset:14848
v_mfma_f32_16x16x32_bf16 v[244:247], v[36:39], v[52:55], v[244:247]
ds_read_b64_tr_b16 v[108:109], v13 offset:14336
ds_read_b64_tr_b16 v[110:111], v13 offset:14848
v_mfma_f32_16x16x32_bf16 v[220:223], v[32:35], v[52:55], v[220:223]
ds_read_b64_tr_b16 v[88:89], v12 offset:12288
ds_read_b64_tr_b16 v[90:91], v12 offset:12800
v_mfma_f32_16x16x32_bf16 v[196:199], v[28:31], v[52:55], v[196:199]
ds_read_b64_tr_b16 v[92:93], v13 offset:12288
ds_read_b64_tr_b16 v[94:95], v13 offset:12800
v_mfma_f32_16x16x32_bf16 v[172:175], v[24:27], v[52:55], v[172:175]
v_mov_b32 v10, 0x3f803f80
v_mov_b32 v11, 0x3f803f80
v_mfma_f32_16x16x32_bf16 v[148:151], v[20:23], v[52:55], v[148:151]
v_mov_b32 v12, 0x3f803f80
v_mov_b32 v13, 0x3f803f80
v_mfma_f32_16x16x32_bf16 v[124:127], v[16:19], v[52:55], v[124:127]
s_waitcnt lgkmcnt(8)
s_nop 0
v_mfma_f32_16x16x32_bf16 v[120:123], v[64:67], v[96:99], v[120:123]
s_nop 0
s_nop 0
v_mfma_f32_16x16x32_bf16 v[144:147], v[68:71], v[96:99], v[144:147]
s_nop 0
s_nop 0
v_mfma_f32_16x16x32_bf16 v[124:127], v[64:67], v[100:103], v[124:127]
s_nop 0
s_waitcnt lgkmcnt(0)
v_mfma_f32_16x16x32_bf16 v[148:151], v[68:71], v[100:103], v[148:151]
v_mul_f32 v48, s44, v120
v_mul_f32 v49, s44, v121
v_mfma_f32_16x16x32_bf16 v[168:171], v[72:75], v[96:99], v[168:171]
v_mul_f32 v50, s44, v122
v_mul_f32 v51, s44, v123
v_mfma_f32_16x16x32_bf16 v[192:195], v[76:79], v[96:99], v[192:195]
v_mul_f32 v52, s44, v144
v_mul_f32 v53, s44, v145
v_mfma_f32_16x16x32_bf16 v[172:175], v[72:75], v[100:103], v[172:175]
v_mul_f32 v54, s44, v146
v_mul_f32 v55, s44, v147
v_mfma_f32_16x16x32_bf16 v[196:199], v[76:79], v[100:103], v[196:199]
v_exp_f32 v48, v48 clamp
v_mfma_f32_16x16x32_bf16 v[216:219], v[80:83], v[96:99], v[216:219]
v_exp_f32 v49, v49 clamp
v_mfma_f32_16x16x32_bf16 v[240:243], v[84:87], v[96:99], v[240:243]
v_exp_f32 v50, v50 clamp
v_mfma_f32_16x16x32_bf16 v[220:223], v[80:83], v[100:103], v[220:223]
v_exp_f32 v51, v51 clamp
v_mfma_f32_16x16x32_bf16 v[244:247], v[84:87], v[100:103], v[244:247]
v_exp_f32 v52, v52 clamp
v_mfma_f32_16x16x32_bf16 v[128:131], v[16:19], v[56:59], v[128:131]
v_exp_f32 v53, v53 clamp
v_mfma_f32_16x16x32_bf16 v[152:155], v[20:23], v[56:59], v[152:155]
v_exp_f32 v54, v54 clamp
v_mfma_f32_16x16x32_bf16 v[176:179], v[24:27], v[56:59], v[176:179]
v_exp_f32 v55, v55 clamp
v_mfma_f32_16x16x32_bf16 v[200:203], v[28:31], v[56:59], v[200:203]
v_max_f32 v120, 0, v120
v_max_f32 v121, 0, v121
v_mfma_f32_16x16x32_bf16 v[224:227], v[32:35], v[56:59], v[224:227]
v_max_f32 v122, 0, v122
v_max_f32 v123, 0, v123
v_mfma_f32_16x16x32_bf16 v[248:251], v[36:39], v[56:59], v[248:251]
v_max_f32 v144, 0, v144
v_max_f32 v145, 0, v145
v_mfma_f32_16x16x32_bf16 v[252:255], v[36:39], v[60:63], v[252:255]
v_max_f32 v146, 0, v146
v_max_f32 v147, 0, v147
v_mfma_f32_16x16x32_bf16 v[228:231], v[32:35], v[60:63], v[228:231]
v_mul_f32 v96, s44, v124
v_mul_f32 v97, s44, v125
v_mfma_f32_16x16x32_bf16 v[204:207], v[28:31], v[60:63], v[204:207]
v_mul_f32 v98, s44, v126
v_mul_f32 v99, s44, v127
v_mfma_f32_16x16x32_bf16 v[180:183], v[24:27], v[60:63], v[180:183]
v_mul_f32 v100, s44, v148
v_mul_f32 v101, s44, v149
v_mfma_f32_16x16x32_bf16 v[156:159], v[20:23], v[60:63], v[156:159]
v_mul_f32 v102, s44, v150
v_mul_f32 v103, s44, v151
v_mfma_f32_16x16x32_bf16 v[132:135], v[16:19], v[60:63], v[132:135]
v_exp_f32 v96, v96 clamp
v_mfma_f32_16x16x32_bf16 v[128:131], v[64:67], v[104:107], v[128:131]
v_exp_f32 v97, v97 clamp
v_mfma_f32_16x16x32_bf16 v[152:155], v[68:71], v[104:107], v[152:155]
v_exp_f32 v98, v98 clamp
v_mfma_f32_16x16x32_bf16 v[176:179], v[72:75], v[104:107], v[176:179]
v_exp_f32 v99, v99 clamp
v_mfma_f32_16x16x32_bf16 v[200:203], v[76:79], v[104:107], v[200:203]
v_exp_f32 v100, v100 clamp
v_mfma_f32_16x16x32_bf16 v[224:227], v[80:83], v[104:107], v[224:227]
v_exp_f32 v101, v101 clamp
v_mfma_f32_16x16x32_bf16 v[248:251], v[84:87], v[104:107], v[248:251]
v_exp_f32 v102, v102 clamp
v_mfma_f32_16x16x32_bf16 v[252:255], v[84:87], v[108:111], v[252:255]
v_exp_f32 v103, v103 clamp
v_mfma_f32_16x16x32_bf16 v[228:231], v[80:83], v[108:111], v[228:231]
v_max_f32 v124, 0, v124
v_max_f32 v125, 0, v125
v_mfma_f32_16x16x32_bf16 v[204:207], v[76:79], v[108:111], v[204:207]
v_max_f32 v126, 0, v126
v_max_f32 v127, 0, v127
v_mfma_f32_16x16x32_bf16 v[180:183], v[72:75], v[108:111], v[180:183]
v_max_f32 v148, 0, v148
v_max_f32 v149, 0, v149
v_mfma_f32_16x16x32_bf16 v[156:159], v[68:71], v[108:111], v[156:159]
v_max_f32 v150, 0, v150
v_max_f32 v151, 0, v151
v_mfma_f32_16x16x32_bf16 v[132:135], v[64:67], v[108:111], v[132:135]
v_mul_f32 v56, s44, v168
v_mul_f32 v57, s44, v169
v_mfma_f32_16x16x32_bf16 v[112:115], v[40:43], v[16:19], v[112:115]
v_mul_f32 v58, s44, v170
v_mul_f32 v59, s44, v171
v_mfma_f32_16x16x32_bf16 v[136:139], v[40:43], v[20:23], v[136:139]
v_mul_f32 v60, s44, v192
v_mul_f32 v61, s44, v193
v_mfma_f32_16x16x32_bf16 v[160:163], v[40:43], v[24:27], v[160:163]
v_mul_f32 v62, s44, v194
v_mul_f32 v63, s44, v195
v_mfma_f32_16x16x32_bf16 v[184:187], v[40:43], v[28:31], v[184:187]
v_exp_f32 v56, v56 clamp
v_mfma_f32_16x16x32_bf16 v[208:211], v[40:43], v[32:35], v[208:211]
v_exp_f32 v57, v57 clamp
v_mfma_f32_16x16x32_bf16 v[232:235], v[40:43], v[36:39], v[232:235]
v_exp_f32 v58, v58 clamp
v_mfma_f32_16x16x32_bf16 v[236:239], v[44:47], v[36:39], v[236:239]
v_exp_f32 v59, v59 clamp
v_mfma_f32_16x16x32_bf16 v[212:215], v[44:47], v[32:35], v[212:215]
v_exp_f32 v60, v60 clamp
v_mfma_f32_16x16x32_bf16 v[188:191], v[44:47], v[28:31], v[188:191]
v_exp_f32 v61, v61 clamp
v_mfma_f32_16x16x32_bf16 v[164:167], v[44:47], v[24:27], v[164:167]
v_exp_f32 v62, v62 clamp
v_mfma_f32_16x16x32_bf16 v[140:143], v[44:47], v[20:23], v[140:143]
v_exp_f32 v63, v63 clamp
v_mfma_f32_16x16x32_bf16 v[116:119], v[44:47], v[16:19], v[116:119]
v_max_f32 v168, 0, v168
v_max_f32 v169, 0, v169
v_mfma_f32_16x16x32_bf16 v[112:115], v[88:91], v[64:67], v[112:115]
v_max_f32 v170, 0, v170
v_max_f32 v171, 0, v171
v_mfma_f32_16x16x32_bf16 v[136:139], v[88:91], v[68:71], v[136:139]
v_max_f32 v192, 0, v192
v_max_f32 v193, 0, v193
v_mfma_f32_16x16x32_bf16 v[160:163], v[88:91], v[72:75], v[160:163]
v_max_f32 v194, 0, v194
v_max_f32 v195, 0, v195
v_mfma_f32_16x16x32_bf16 v[184:187], v[88:91], v[76:79], v[184:187]
v_mul_f32 v104, s44, v172
v_mul_f32 v105, s44, v173
v_mfma_f32_16x16x32_bf16 v[208:211], v[88:91], v[80:83], v[208:211]
v_mul_f32 v106, s44, v174
v_mul_f32 v107, s44, v175
v_mfma_f32_16x16x32_bf16 v[232:235], v[88:91], v[84:87], v[232:235]
v_mul_f32 v108, s44, v196
v_mul_f32 v109, s44, v197
v_mfma_f32_16x16x32_bf16 v[236:239], v[92:95], v[84:87], v[236:239]
v_mul_f32 v110, s44, v198
v_mul_f32 v111, s44, v199
v_mfma_f32_16x16x32_bf16 v[212:215], v[92:95], v[80:83], v[212:215]
v_exp_f32 v104, v104 clamp
v_mfma_f32_16x16x32_bf16 v[188:191], v[92:95], v[76:79], v[188:191]
v_exp_f32 v105, v105 clamp
v_mfma_f32_16x16x32_bf16 v[164:167], v[92:95], v[72:75], v[164:167]
v_exp_f32 v106, v106 clamp
v_mfma_f32_16x16x32_bf16 v[140:143], v[92:95], v[68:71], v[140:143]
v_exp_f32 v107, v107 clamp
v_mfma_f32_16x16x32_bf16 v[116:119], v[92:95], v[64:67], v[116:119]
v_exp_f32 v108, v108 clamp
v_pk_add_f32 v[120:121], v[120:121], v[48:49]
v_pk_add_f32 v[122:123], v[122:123], v[50:51]
v_pk_add_f32 v[144:145], v[144:145], v[52:53]
v_pk_add_f32 v[146:147], v[146:147], v[54:55]
v_pk_add_f32 v[120:121], v[120:121], s[42:43]
v_pk_add_f32 v[122:123], v[122:123], s[42:43]
v_pk_add_f32 v[144:145], v[144:145], s[42:43]
v_pk_add_f32 v[146:147], v[146:147], s[42:43]
v_cvt_pk_bf16_f32 v32, v120, v121
v_cvt_pk_bf16_f32 v33, v122, v123
v_cvt_pk_bf16_f32 v34, v144, v145
v_cvt_pk_bf16_f32 v35, v146, v147
v_cvt_pk_bf16_f32 v36, v128, v129
v_cvt_pk_bf16_f32 v37, v130, v131
v_cvt_pk_bf16_f32 v38, v152, v153
v_cvt_pk_bf16_f32 v39, v154, v155
v_mfma_f32_16x16x32_bf16 v[72:75], v[10:13], v[32:35], 0
v_pk_add_f32 v[124:125], v[124:125], v[96:97]
v_pk_add_f32 v[126:127], v[126:127], v[98:99]
v_pk_add_f32 v[148:149], v[148:149], v[100:101]
v_pk_add_f32 v[150:151], v[150:151], v[102:103]
v_mfma_f32_16x16x32_bf16 v[64:67], v[32:35], v[36:39], 0
v_pk_add_f32 v[124:125], v[124:125], s[42:43]
v_pk_add_f32 v[126:127], v[126:127], s[42:43]
v_pk_add_f32 v[148:149], v[148:149], s[42:43]
v_pk_add_f32 v[150:151], v[150:151], s[42:43]
v_cvt_pk_bf16_f32 v40, v124, v125
v_cvt_pk_bf16_f32 v41, v126, v127
v_cvt_pk_bf16_f32 v42, v148, v149
v_cvt_pk_bf16_f32 v43, v150, v151
v_cvt_pk_bf16_f32 v44, v132, v133
v_cvt_pk_bf16_f32 v45, v134, v135
v_cvt_pk_bf16_f32 v46, v156, v157
v_cvt_pk_bf16_f32 v47, v158, v159
v_mfma_f32_16x16x32_bf16 v[76:79], v[10:13], v[40:43], 0
s_nop 0
s_nop 0
v_mfma_f32_16x16x32_bf16 v[68:71], v[40:43], v[44:47], 0
s_cmp_ge_u32 s50, 63
s_cbranch_scc1 L_kv_done
v_pk_add_f32 v[168:169], v[168:169], v[56:57]
v_pk_add_f32 v[170:171], v[170:171], v[58:59]
v_pk_add_f32 v[192:193], v[192:193], v[60:61]
v_pk_add_f32 v[194:195], v[194:195], v[62:63]
v_pk_add_f32 v[168:169], v[168:169], s[42:43]
v_pk_add_f32 v[170:171], v[170:171], s[42:43]
v_pk_add_f32 v[192:193], v[192:193], s[42:43]
v_pk_add_f32 v[194:195], v[194:195], s[42:43]
v_cvt_pk_bf16_f32 v32, v168, v169
v_cvt_pk_bf16_f32 v33, v170, v171
v_cvt_pk_bf16_f32 v34, v192, v193
v_cvt_pk_bf16_f32 v35, v194, v195
v_cvt_pk_bf16_f32 v36, v176, v177
v_cvt_pk_bf16_f32 v37, v178, v179
v_cvt_pk_bf16_f32 v38, v200, v201
v_cvt_pk_bf16_f32 v39, v202, v203
v_mfma_f32_16x16x32_bf16 v[72:75], v[10:13], v[32:35], v[72:75]
v_exp_f32 v109, v109 clamp
v_exp_f32 v110, v110 clamp
v_exp_f32 v111, v111 clamp
v_max_f32 v172, 0, v172
v_max_f32 v173, 0, v173
v_mfma_f32_16x16x32_bf16 v[64:67], v[32:35], v[36:39], v[64:67]
v_max_f32 v174, 0, v174
v_max_f32 v175, 0, v175
v_max_f32 v196, 0, v196
v_max_f32 v197, 0, v197
v_max_f32 v198, 0, v198
v_max_f32 v199, 0, v199
v_pk_add_f32 v[172:173], v[172:173], v[104:105]
v_pk_add_f32 v[174:175], v[174:175], v[106:107]
v_pk_add_f32 v[196:197], v[196:197], v[108:109]
v_pk_add_f32 v[198:199], v[198:199], v[110:111]
v_pk_add_f32 v[172:173], v[172:173], s[42:43]
v_pk_add_f32 v[174:175], v[174:175], s[42:43]
v_pk_add_f32 v[196:197], v[196:197], s[42:43]
v_pk_add_f32 v[198:199], v[198:199], s[42:43]
v_cvt_pk_bf16_f32 v40, v172, v173
v_cvt_pk_bf16_f32 v41, v174, v175
v_cvt_pk_bf16_f32 v42, v196, v197
v_cvt_pk_bf16_f32 v43, v198, v199
v_cvt_pk_bf16_f32 v44, v180, v181
v_cvt_pk_bf16_f32 v45, v182, v183
v_cvt_pk_bf16_f32 v46, v204, v205
v_cvt_pk_bf16_f32 v47, v206, v207
v_mfma_f32_16x16x32_bf16 v[76:79], v[10:13], v[40:43], v[76:79]
v_pk_mul_f32 v[16:17], v[216:217], s[44:45]
v_pk_mul_f32 v[18:19], v[218:219], s[44:45]
v_pk_mul_f32 v[20:21], v[240:241], s[44:45]
v_pk_mul_f32 v[22:23], v[242:243], s[44:45]
v_mfma_f32_16x16x32_bf16 v[68:71], v[40:43], v[44:47], v[68:71]
v_exp_f32 v16, v16 clamp
v_exp_f32 v17, v17 clamp
v_exp_f32 v18, v18 clamp
v_exp_f32 v19, v19 clamp
v_exp_f32 v20, v20 clamp
v_exp_f32 v21, v21 clamp
v_exp_f32 v22, v22 clamp
v_exp_f32 v23, v23 clamp
v_max_f32 v216, 0, v216
v_max_f32 v217, 0, v217
v_max_f32 v218, 0, v218
v_max_f32 v219, 0, v219
v_max_f32 v240, 0, v240
v_max_f32 v241, 0, v241
v_max_f32 v242, 0, v242
v_max_f32 v243, 0, v243
v_pk_add_f32 v[216:217], v[216:217], v[16:17]
v_pk_add_f32 v[218:219], v[218:219], v[18:19]
v_pk_add_f32 v[240:241], v[240:241], v[20:21]
v_pk_add_f32 v[242:243], v[242:243], v[22:23]
v_pk_add_f32 v[216:217], v[216:217], s[42:43]
v_pk_add_f32 v[218:219], v[218:219], s[42:43]
v_pk_add_f32 v[240:241], v[240:241], s[42:43]
v_pk_add_f32 v[242:243], v[242:243], s[42:43]
v_cvt_pk_bf16_f32 v32, v216, v217
v_cvt_pk_bf16_f32 v33, v218, v219
v_cvt_pk_bf16_f32 v34, v240, v241
v_cvt_pk_bf16_f32 v35, v242, v243
v_cvt_pk_bf16_f32 v36, v224, v225
v_cvt_pk_bf16_f32 v37, v226, v227
v_cvt_pk_bf16_f32 v38, v248, v249
v_cvt_pk_bf16_f32 v39, v250, v251
v_mfma_f32_16x16x32_bf16 v[72:75], v[10:13], v[32:35], v[72:75]
v_pk_mul_f32 v[24:25], v[220:221], s[44:45]
v_pk_mul_f32 v[26:27], v[222:223], s[44:45]
v_pk_mul_f32 v[28:29], v[244:245], s[44:45]
v_pk_mul_f32 v[30:31], v[246:247], s[44:45]
v_mfma_f32_16x16x32_bf16 v[64:67], v[32:35], v[36:39], v[64:67]
v_exp_f32 v24, v24 clamp
v_exp_f32 v25, v25 clamp
v_exp_f32 v26, v26 clamp
v_exp_f32 v27, v27 clamp
v_exp_f32 v28, v28 clamp
v_exp_f32 v29, v29 clamp
v_exp_f32 v30, v30 clamp
v_exp_f32 v31, v31 clamp
v_max_f32 v220, 0, v220
v_max_f32 v221, 0, v221
v_max_f32 v222, 0, v222
v_max_f32 v223, 0, v223
v_max_f32 v244, 0, v244
v_max_f32 v245, 0, v245
v_max_f32 v246, 0, v246
v_max_f32 v247, 0, v247
v_pk_add_f32 v[220:221], v[220:221], v[24:25]
v_pk_add_f32 v[222:223], v[222:223], v[26:27]
v_pk_add_f32 v[244:245], v[244:245], v[28:29]
v_pk_add_f32 v[246:247], v[246:247], v[30:31]
v_pk_add_f32 v[220:221], v[220:221], s[42:43]
v_pk_add_f32 v[222:223], v[222:223], s[42:43]
v_pk_add_f32 v[244:245], v[244:245], s[42:43]
v_pk_add_f32 v[246:247], v[246:247], s[42:43]
v_cvt_pk_bf16_f32 v40, v220, v221
v_cvt_pk_bf16_f32 v41, v222, v223
v_cvt_pk_bf16_f32 v42, v244, v245
v_cvt_pk_bf16_f32 v43, v246, v247
v_cvt_pk_bf16_f32 v44, v228, v229
v_cvt_pk_bf16_f32 v45, v230, v231
v_cvt_pk_bf16_f32 v46, v252, v253
v_cvt_pk_bf16_f32 v47, v254, v255
v_mfma_f32_16x16x32_bf16 v[76:79], v[10:13], v[40:43], v[76:79]
s_nop 0
s_nop 0
v_mfma_f32_16x16x32_bf16 v[68:71], v[40:43], v[44:47], v[68:71]
L_kv_done:
s_lshl2_add_u32 s38, s26, 156672
v_mov_b32 v48, 1
v_mov_b32 v50, s38
v_xor_b32_e64 v51, 8, v50
s_mul_i32 s38, s48, -3072
v_add_u32_e64 v1, s38, v1
s_lshl_b32 s38, s48, 10
s_add_u32 s22, s22, s38
ds_write_b128 v4, v[64:67] offset:0
ds_write_b128 v4, v[68:71] offset:256
ds_write_b32 v50, v48 offset:16
v_cndmask_b32 v72, v72, v76, s[12:13]
s_mov_b32 exec_hi, 0
s_nop 0
buffer_atomic_add_f32 v72, v15, s[64:67], s23 offen
s_mov_b64 exec, -1
s_nop 0
v_pk_mul_f32 v[16:17], v[112:113], s[44:45]
v_pk_mul_f32 v[18:19], v[114:115], s[44:45]
v_pk_mul_f32 v[20:21], v[136:137], s[44:45]
v_pk_mul_f32 v[22:23], v[138:139], s[44:45]
v_exp_f32 v16, v16 clamp
v_exp_f32 v17, v17 clamp
v_exp_f32 v18, v18 clamp
v_exp_f32 v19, v19 clamp
v_exp_f32 v20, v20 clamp
v_exp_f32 v21, v21 clamp
v_exp_f32 v22, v22 clamp
v_exp_f32 v23, v23 clamp
v_max_f32 v112, 0, v112
v_max_f32 v113, 0, v113
v_max_f32 v114, 0, v114
v_max_f32 v115, 0, v115
v_max_f32 v136, 0, v136
v_max_f32 v137, 0, v137
v_max_f32 v138, 0, v138
v_max_f32 v139, 0, v139
v_pk_add_f32 v[112:113], v[112:113], v[16:17]
v_pk_add_f32 v[114:115], v[114:115], v[18:19]
v_pk_add_f32 v[136:137], v[136:137], v[20:21]
v_pk_add_f32 v[138:139], v[138:139], v[22:23]
v_pk_add_f32 v[112:113], v[112:113], s[42:43]
v_pk_add_f32 v[114:115], v[114:115], s[42:43]
v_pk_add_f32 v[136:137], v[136:137], s[42:43]
v_pk_add_f32 v[138:139], v[138:139], s[42:43]
v_cvt_pk_bf16_f32 v80, v112, v113
v_cvt_pk_bf16_f32 v81, v114, v115
v_cvt_pk_bf16_f32 v82, v136, v137
v_cvt_pk_bf16_f32 v83, v138, v139
ds_read_b32 v49, v51 offset:16
ds_read_b32 v52, v1 offset:0
ds_read_b32 v53, v1 offset:256
ds_read_b32 v54, v1 offset:512
ds_read_b32 v55, v1 offset:768
ds_read_b32 v56, v1 offset:4096
ds_read_b32 v57, v1 offset:4352
ds_read_b32 v58, v1 offset:4608
ds_read_b32 v59, v1 offset:4864
v_pk_mul_f32 v[24:25], v[116:117], s[44:45]
v_pk_mul_f32 v[26:27], v[118:119], s[44:45]
v_pk_mul_f32 v[28:29], v[140:141], s[44:45]
v_pk_mul_f32 v[30:31], v[142:143], s[44:45]
v_permlane16_swap_b32 v80, v82
v_permlane16_swap_b32 v81, v83
s_waitcnt lgkmcnt(0)
v_readfirstlane_b32 s38, v49
s_nop 0
s_cmp_eq_u32 s38, 1
s_cbranch_scc0 L_pair
L_pair_back:
v_add_f32 v52, v52, v56
v_add_f32 v53, v53, v57
v_add_f32 v54, v54, v58
v_add_f32_e64 v55, v55, v59
buffer_atomic_add_f32 v52, v15, s[64:67], s22 offen offset:0
buffer_atomic_add_f32 v53, v15, s[64:67], s22 offen offset:256
buffer_atomic_add_f32 v54, v15, s[64:67], s22 offen offset:512
buffer_atomic_add_f32 v55, v15, s[64:67], s22 offen offset:768
v_exp_f32 v24, v24 clamp
v_exp_f32 v25, v25 clamp
v_exp_f32 v26, v26 clamp
v_exp_f32 v27, v27 clamp
v_exp_f32 v28, v28 clamp
v_exp_f32 v29, v29 clamp
v_exp_f32 v30, v30 clamp
v_exp_f32 v31, v31 clamp
v_max_f32 v116, 0, v116
v_max_f32 v117, 0, v117
v_max_f32 v118, 0, v118
v_max_f32 v119, 0, v119
v_max_f32 v140, 0, v140
v_max_f32 v141, 0, v141
v_max_f32 v142, 0, v142
v_max_f32 v143, 0, v143
v_pk_add_f32 v[116:117], v[116:117], v[24:25]
v_pk_add_f32 v[118:119], v[118:119], v[26:27]
v_pk_add_f32 v[140:141], v[140:141], v[28:29]
v_pk_add_f32 v[142:143], v[142:143], v[30:31]
v_pk_add_f32 v[116:117], v[116:117], s[42:43]
v_pk_add_f32 v[118:119], v[118:119], s[42:43]
v_pk_add_f32 v[140:141], v[140:141], s[42:43]
v_pk_add_f32 v[142:143], v[142:143], s[42:43]
v_cvt_pk_bf16_f32 v84, v116, v117
v_cvt_pk_bf16_f32 v85, v118, v119
v_cvt_pk_bf16_f32 v86, v140, v141
v_cvt_pk_bf16_f32 v87, v142, v143
v_pk_mul_f32 v[16:17], v[160:161], s[44:45]
v_pk_mul_f32 v[18:19], v[162:163], s[44:45]
v_pk_mul_f32 v[20:21], v[184:185], s[44:45]
v_pk_mul_f32 v[22:23], v[186:187], s[44:45]
v_permlane16_swap_b32 v84, v86
v_permlane16_swap_b32 v85, v87
v_exp_f32 v16, v16 clamp
v_exp_f32 v17, v17 clamp
v_exp_f32 v18, v18 clamp
v_exp_f32 v19, v19 clamp
v_exp_f32 v20, v20 clamp
v_exp_f32 v21, v21 clamp
v_exp_f32 v22, v22 clamp
v_exp_f32 v23, v23 clamp
v_max_f32 v160, 0, v160
v_max_f32 v161, 0, v161
v_max_f32 v162, 0, v162
v_max_f32 v163, 0, v163
v_max_f32 v184, 0, v184
v_max_f32 v185, 0, v185
v_max_f32 v186, 0, v186
v_max_f32 v187, 0, v187
v_pk_add_f32 v[160:161], v[160:161], v[16:17]
v_pk_add_f32 v[162:163], v[162:163], v[18:19]
v_pk_add_f32 v[184:185], v[184:185], v[20:21]
v_pk_add_f32 v[186:187], v[186:187], v[22:23]
v_pk_add_f32 v[160:161], v[160:161], s[42:43]
v_pk_add_f32 v[162:163], v[162:163], s[42:43]
v_pk_add_f32 v[184:185], v[184:185], s[42:43]
v_pk_add_f32 v[186:187], v[186:187], s[42:43]
v_cvt_pk_bf16_f32 v88, v160, v161
v_cvt_pk_bf16_f32 v89, v162, v163
v_cvt_pk_bf16_f32 v90, v184, v185
v_cvt_pk_bf16_f32 v91, v186, v187
v_pk_mul_f32 v[24:25], v[164:165], s[44:45]
v_pk_mul_f32 v[26:27], v[166:167], s[44:45]
v_pk_mul_f32 v[28:29], v[188:189], s[44:45]
v_pk_mul_f32 v[30:31], v[190:191], s[44:45]
v_permlane16_swap_b32 v88, v90
v_permlane16_swap_b32 v89, v91
v_exp_f32 v24, v24 clamp
v_exp_f32 v25, v25 clamp
v_exp_f32 v26, v26 clamp
v_exp_f32 v27, v27 clamp
v_exp_f32 v28, v28 clamp
v_exp_f32 v29, v29 clamp
v_exp_f32 v30, v30 clamp
v_exp_f32 v31, v31 clamp
v_max_f32 v164, 0, v164
v_max_f32 v165, 0, v165
v_max_f32 v166, 0, v166
v_max_f32 v167, 0, v167
v_max_f32 v188, 0, v188
v_max_f32 v189, 0, v189
v_max_f32 v190, 0, v190
v_max_f32 v191, 0, v191
v_pk_add_f32 v[164:165], v[164:165], v[24:25]
v_pk_add_f32 v[166:167], v[166:167], v[26:27]
v_pk_add_f32 v[188:189], v[188:189], v[28:29]
v_pk_add_f32 v[190:191], v[190:191], v[30:31]
v_pk_add_f32 v[164:165], v[164:165], s[42:43]
v_pk_add_f32 v[166:167], v[166:167], s[42:43]
v_pk_add_f32 v[188:189], v[188:189], s[42:43]
v_pk_add_f32 v[190:191], v[190:191], s[42:43]
v_cvt_pk_bf16_f32 v92, v164, v165
v_cvt_pk_bf16_f32 v93, v166, v167
v_cvt_pk_bf16_f32 v94, v188, v189
v_cvt_pk_bf16_f32 v95, v190, v191
v_pk_mul_f32 v[16:17], v[208:209], s[44:45]
v_pk_mul_f32 v[18:19], v[210:211], s[44:45]
v_pk_mul_f32 v[20:21], v[232:233], s[44:45]
v_pk_mul_f32 v[22:23], v[234:235], s[44:45]
v_permlane16_swap_b32 v92, v94
v_permlane16_swap_b32 v93, v95
v_exp_f32 v16, v16 clamp
v_exp_f32 v17, v17 clamp
v_exp_f32 v18, v18 clamp
v_exp_f32 v19, v19 clamp
v_exp_f32 v20, v20 clamp
v_exp_f32 v21, v21 clamp
v_exp_f32 v22, v22 clamp
v_exp_f32 v23, v23 clamp
v_max_f32 v208, 0, v208
v_max_f32 v209, 0, v209
v_max_f32 v210, 0, v210
v_max_f32 v211, 0, v211
v_max_f32 v232, 0, v232
v_max_f32 v233, 0, v233
v_max_f32 v234, 0, v234
v_max_f32 v235, 0, v235
v_pk_add_f32 v[208:209], v[208:209], v[16:17]
v_pk_add_f32 v[210:211], v[210:211], v[18:19]
v_pk_add_f32 v[232:233], v[232:233], v[20:21]
v_pk_add_f32 v[234:235], v[234:235], v[22:23]
v_pk_add_f32 v[208:209], v[208:209], s[42:43]
v_pk_add_f32 v[210:211], v[210:211], s[42:43]
v_pk_add_f32 v[232:233], v[232:233], s[42:43]
v_pk_add_f32 v[234:235], v[234:235], s[42:43]
v_cvt_pk_bf16_f32 v96, v208, v209
v_cvt_pk_bf16_f32 v97, v210, v211
v_cvt_pk_bf16_f32 v98, v232, v233
v_cvt_pk_bf16_f32 v99, v234, v235
v_pk_mul_f32 v[24:25], v[212:213], s[44:45]
v_pk_mul_f32 v[26:27], v[214:215], s[44:45]
v_pk_mul_f32 v[28:29], v[236:237], s[44:45]
v_pk_mul_f32 v[30:31], v[238:239], s[44:45]
v_permlane16_swap_b32 v96, v98
v_permlane16_swap_b32 v97, v99
v_exp_f32 v24, v24 clamp
v_exp_f32 v25, v25 clamp
v_exp_f32 v26, v26 clamp
v_exp_f32 v27, v27 clamp
v_exp_f32 v28, v28 clamp
v_exp_f32 v29, v29 clamp
v_exp_f32 v30, v30 clamp
v_exp_f32 v31, v31 clamp
v_max_f32 v212, 0, v212
v_max_f32 v213, 0, v213
v_max_f32 v214, 0, v214
v_max_f32 v215, 0, v215
v_max_f32 v236, 0, v236
v_max_f32 v237, 0, v237
v_max_f32 v238, 0, v238
v_max_f32 v239, 0, v239
v_pk_add_f32 v[212:213], v[212:213], v[24:25]
v_pk_add_f32 v[214:215], v[214:215], v[26:27]
v_pk_add_f32 v[236:237], v[236:237], v[28:29]
v_pk_add_f32 v[238:239], v[238:239], v[30:31]
v_pk_add_f32 v[212:213], v[212:213], s[42:43]
v_pk_add_f32 v[214:215], v[214:215], s[42:43]
v_pk_add_f32 v[236:237], v[236:237], s[42:43]
v_pk_add_f32 v[238:239], v[238:239], s[42:43]
v_cvt_pk_bf16_f32 v100, v212, v213
v_cvt_pk_bf16_f32 v101, v214, v215
v_cvt_pk_bf16_f32 v102, v236, v237
v_cvt_pk_bf16_f32 v103, v238, v239
s_nop 0
v_permlane16_swap_b32 v100, v102
v_permlane16_swap_b32 v101, v103
v_mov_b32 v17, 1
s_cmp_eq_u32 s26, 3
s_mov_b32 exec_lo, 0x7ff
s_mov_b32 exec_hi, 0
s_waitcnt vmcnt(0)
s_barrier
s_cbranch_scc0 L_noksig
buffer_store_dword v17, v0, s[64:67], s51 offen sc1
L_noksig:
s_mov_b64 exec, -1
L_ostage:
s_and_b32 s38, s2, 6
s_lshr_b32 s39, s2, 5
s_lshl2_add_u32 s34, s38, s39
s_and_b32 s38, s2, 1
s_bfe_u32 s35, s2, 0x20003
s_lshl2_add_u32 s35, s38, s35
s_mov_b32 s80, s20
s_mov_b32 s81, s21
s_mov_b32 s82, 2097152
s_mov_b32 s83, 0x20000
s_lshl3_add_u32 s38, s34, s35
s_lshl_b32 s38, s38, 8
s_add_u32 s38, s38, 9527296
s_add_u32 s10, s24, s38
s_addc_u32 s11, s25, 0
s_lshl3_add_u32 s38, s34, s35
s_lshl_b32 s38, s38, 7
s_add_u32 s38, s38, 9494528
s_add_u32 s18, s24, s38
s_addc_u32 s19, s25, 0
v_mov_b32 v17, 1
v_lshrrev_b32 v20, 3, v2
v_and_b32 v21, 7, v2
v_lshrrev_b32 v18, 1, v20
v_and_b32 v19, 1, v20
v_lshl_or_b32 v18, v19, 2, v18
v_and_b32 v19, 3, v21
v_lshlrev_b32 v19, 1, v19
v_xor_b32 v18, v18, v19
v_lshlrev_b32 v18, 4, v18
v_lshl_add_u32 v18, v20, 7, v18
s_lshl_b32 s38, s26, 10
v_add_u32 v18, s38, v18
v_lshrrev_b32 v19, 2, v21
v_mul_u32_u24 v26, 40960, v19
v_add_u32 v26, v26, v18
v_add_u32 v26, 57344, v26
v_xor_b32 v27, 16, v26
v_mul_u32_u24 v28, 4096, v19
v_add_u32 v28, v28, v18
v_add_u32 v28, 102400, v28
v_xor_b32 v29, 16, v28
v_lshlrev_b32 v19, 2, v20
s_lshl_b32 s44, s34, 8
s_lshl_b32 s38, s26, 5
s_add_u32 s44, s44, s38
s_add_u32 s44, s44, 7864320
v_lshlrev_b32 v16, 10, v20
v_lshl_add_u32 v16, v21, 4, v16
s_lshl_b32 s40, s34, 16
s_lshl_b32 s39, s26, 13
s_add_u32 s40, s40, s39
s_lshl_b32 s39, s35, 7
s_add_u32 s40, s40, s39
s_xor_b32 s41, s40, 32768
s_xor_b32 s45, s44, 128
s_mov_b32 s42, 0x42200000
s_xor_b32 s8, s8, 4096
s_xor_b32 s9, s9, 256
s_setprio 2
s_cmp_eq_u32 s26, 0
s_cbranch_scc0 L_kmr
s_mov_b32 s47, 131072
L_km_loop:
s_load_dwordx16 s[84:99], s[16:17], 0 glc
L_km_chk:
s_waitcnt lgkmcnt(0)
s_and_b64 s[84:85], s[84:85], s[86:87]
s_and_b64 s[88:89], s[88:89], s[90:91]
s_and_b64 s[92:93], s[92:93], s[84:85]
s_and_b64 s[88:89], s[88:89], s[92:93]
s_and_b32 s88, s88, s94
s_and_b32 s88, s88, s89
s_cbranch_scc1 L_km_done
s_sub_u32 s47, s47, 1
s_cmp_lg_u32 s47, 0
s_cbranch_scc1 L_km_loop
L_km_done:
ds_write_b32 v6, v17 offset:8
s_branch L_kmr_done
L_kmr:
s_mov_b32 s47, 1048576
L_kmr_loop:
ds_read_b32 v25, v6 offset:8
s_waitcnt lgkmcnt(0)
v_readfirstlane_b32 s38, v25
s_nop 0
s_cmp_eq_u32 s38, 1
s_cbranch_scc1 L_kmr_done
s_sub_u32 s47, s47, 1
s_cmp_lg_u32 s47, 0
s_cbranch_scc1 L_kmr_loop
L_kmr_done:
buffer_load_dwordx4 v[32:35], v14, s[64:67], s8 offen offset:0 sc1
buffer_load_dwordx4 v[36:39], v14, s[64:67], s8 offen offset:1024 sc1
buffer_load_dwordx4 v[40:43], v5, s[64:67], s9 offen offset:0 sc1
buffer_load_dwordx4 v[44:47], v5, s[64:67], s9 offen offset:16 sc1
s_waitcnt vmcnt(0)
s_nop 0
v_cvt_pk_bf16_f32 v32, v32, v33
v_cvt_pk_bf16_f32 v33, v34, v35
v_cvt_pk_bf16_f32 v34, v36, v37
v_cvt_pk_bf16_f32 v35, v38, v39
v_cvt_pk_bf16_f32 v40, v40, v41
v_cvt_pk_bf16_f32 v41, v42, v43
v_cvt_pk_bf16_f32 v42, v44, v45
v_cvt_pk_bf16_f32 v43, v46, v47
v_cndmask_b32 v48, v32, v40, s[12:13]
v_cndmask_b32 v49, v33, v41, s[12:13]
v_cndmask_b32 v50, v34, v42, s[12:13]
v_cndmask_b32 v51, v35, v43, s[12:13]
v_cndmask_b32 v52, v40, v32, s[12:13]
v_cndmask_b32 v53, v41, v33, s[12:13]
v_cndmask_b32 v54, v42, v34, s[12:13]
v_cndmask_b32 v55, v43, v35, s[12:13]
v_mfma_f32_32x32x16_bf16 v[112:127], v[48:51], v[80:83], 0
s_nop 0
s_nop 0
v_mfma_f32_32x32x16_bf16 v[128:143], v[52:55], v[84:87], 0
v_mfma_f32_32x32x16_bf16 v[144:159], v[48:51], v[88:91], 0
v_mfma_f32_32x32x16_bf16 v[160:175], v[52:55], v[92:95], 0
v_mfma_f32_32x32x16_bf16 v[176:191], v[48:51], v[96:99], 0
v_mfma_f32_32x32x16_bf16 v[192:207], v[52:55], v[100:103], 0
s_nop 5
v_add_f32 v120, s43, v120
v_rcp_f32 v120, v120
s_nop 0
v_mul_f32 v112, v112, v120
v_mul_f32 v113, v113, v120
v_mul_f32 v114, v114, v120
v_mul_f32 v115, v115, v120
v_mul_f32 v116, v116, v120
v_mul_f32 v117, v117, v120
v_mul_f32 v118, v118, v120
v_mul_f32 v119, v119, v120
v_cvt_pk_bf16_f32 v80, v112, v113
v_cvt_pk_bf16_f32 v81, v114, v115
v_cvt_pk_bf16_f32 v82, v116, v117
v_cvt_pk_bf16_f32 v83, v118, v119
v_add_f32 v128, s43, v128
v_rcp_f32 v128, v128
buffer_store_dwordx4 v[80:83], v14, s[68:71], s4 offen offset:0 sc1
v_mul_f32 v136, v136, v128
v_mul_f32 v137, v137, v128
v_mul_f32 v138, v138, v128
v_mul_f32 v139, v139, v128
v_mul_f32 v140, v140, v128
v_mul_f32 v141, v141, v128
v_mul_f32 v142, v142, v128
v_mul_f32 v143, v143, v128
v_cvt_pk_bf16_f32 v84, v136, v137
v_cvt_pk_bf16_f32 v85, v138, v139
v_cvt_pk_bf16_f32 v86, v140, v141
v_cvt_pk_bf16_f32 v87, v142, v143
v_add_f32 v152, s43, v152
v_rcp_f32 v152, v152
buffer_store_dwordx4 v[84:87], v14, s[68:71], s4 offen offset:1024 sc1
v_mul_f32 v144, v144, v152
v_mul_f32 v145, v145, v152
v_mul_f32 v146, v146, v152
v_mul_f32 v147, v147, v152
v_mul_f32 v148, v148, v152
v_mul_f32 v149, v149, v152
v_mul_f32 v150, v150, v152
v_mul_f32 v151, v151, v152
v_cvt_pk_bf16_f32 v88, v144, v145
v_cvt_pk_bf16_f32 v89, v146, v147
v_cvt_pk_bf16_f32 v90, v148, v149
v_cvt_pk_bf16_f32 v91, v150, v151
v_add_f32 v160, s43, v160
v_rcp_f32 v160, v160
buffer_store_dwordx4 v[88:91], v14, s[68:71], s5 offen offset:0 sc1
v_mul_f32 v168, v168, v160
v_mul_f32 v169, v169, v160
v_mul_f32 v170, v170, v160
v_mul_f32 v171, v171, v160
v_mul_f32 v172, v172, v160
v_mul_f32 v173, v173, v160
v_mul_f32 v174, v174, v160
v_mul_f32 v175, v175, v160
v_cvt_pk_bf16_f32 v92, v168, v169
v_cvt_pk_bf16_f32 v93, v170, v171
v_cvt_pk_bf16_f32 v94, v172, v173
v_cvt_pk_bf16_f32 v95, v174, v175
v_add_f32 v184, s43, v184
v_rcp_f32 v184, v184
buffer_store_dwordx4 v[92:95], v14, s[68:71], s5 offen offset:1024 sc1
v_mul_f32 v176, v176, v184
v_mul_f32 v177, v177, v184
v_mul_f32 v178, v178, v184
v_mul_f32 v179, v179, v184
v_mul_f32 v180, v180, v184
v_mul_f32 v181, v181, v184
v_mul_f32 v182, v182, v184
v_mul_f32 v183, v183, v184
v_cvt_pk_bf16_f32 v96, v176, v177
v_cvt_pk_bf16_f32 v97, v178, v179
v_cvt_pk_bf16_f32 v98, v180, v181
v_cvt_pk_bf16_f32 v99, v182, v183
v_add_f32 v192, s43, v192
v_rcp_f32 v192, v192
buffer_store_dwordx4 v[96:99], v14, s[68:71], s6 offen offset:0 sc1
v_mul_f32 v200, v200, v192
v_mul_f32 v201, v201, v192
v_mul_f32 v202, v202, v192
v_mul_f32 v203, v203, v192
v_mul_f32 v204, v204, v192
v_mul_f32 v205, v205, v192
v_mul_f32 v206, v206, v192
v_mul_f32 v207, v207, v192
v_cvt_pk_bf16_f32 v100, v200, v201
v_cvt_pk_bf16_f32 v101, v202, v203
v_cvt_pk_bf16_f32 v102, v204, v205
v_cvt_pk_bf16_f32 v103, v206, v207
buffer_store_dwordx4 v[100:103], v14, s[68:71], s6 offen offset:1024 sc1
s_waitcnt vmcnt(0)
s_mov_b32 exec_lo, 1
s_mov_b32 exec_hi, 0
ds_add_rtn_u32 v25, v6, v17 offset:0
s_waitcnt lgkmcnt(0)
v_readfirstlane_b32 s38, v25
s_nop 0
s_cmp_eq_u32 s38, 3
s_cbranch_scc0 L_noosig
s_mov_b32 exec_lo, s15
buffer_store_dword v17, v0, s[64:67], s7 offen sc1
L_noosig:
s_mov_b64 exec, -1
s_setprio 0
s_branch L_owait
L_pair:
s_mov_b32 s47, 1048576
L_pair_loop:
ds_read_b32 v49, v51 offset:16
ds_read_b32 v52, v1 offset:0
ds_read_b32 v53, v1 offset:256
ds_read_b32 v54, v1 offset:512
ds_read_b32 v55, v1 offset:768
ds_read_b32 v56, v1 offset:4096
ds_read_b32 v57, v1 offset:4352
ds_read_b32 v58, v1 offset:4608
ds_read_b32 v59, v1 offset:4864
s_waitcnt lgkmcnt(0)
v_readfirstlane_b32 s38, v49
s_nop 0
s_cmp_eq_u32 s38, 1
s_cbranch_scc1 L_pair_done
s_sub_u32 s47, s47, 1
s_cmp_lg_u32 s47, 0
s_cbranch_scc1 L_pair_loop
L_pair_done:
s_branch L_pair_back
L_end:
s_endpgm
.section .rodata,"a"
.p2align 6
.amdhsa_kernel gated_mix__linear_attn_block__glu_gated_swiglu__prompt_kernel
  .amdhsa_next_free_vgpr 256
  .amdhsa_next_free_sgpr 102
  .amdhsa_accum_offset 256
  .amdhsa_group_segment_fixed_size 0
  .amdhsa_kernarg_size 88
  .amdhsa_user_sgpr_count 2
  .amdhsa_user_sgpr_kernarg_segment_ptr 1
  .amdhsa_system_sgpr_workgroup_id_x 1
.end_amdhsa_kernel
```
